```python
import torch

def _softmax(x, axis=-1):
    return torch.softmax(x, dim=axis)
def _gelu(x):
    return torch.nn.functional.gelu(x, approximate="tanh")
def _silu(x):
    return torch.nn.functional.silu(x)
def _sigmoid(x):
    return torch.sigmoid(x)
def _layernorm(x, axis=-1, eps=1e-5):
    m = x.mean(dim=axis, keepdim=True)
    v = x.var(dim=axis, keepdim=True, unbiased=False)
    return (x - m) / torch.sqrt(v + eps)
def _scatter_add(tgt, idx, src, axis=0):
    return tgt.clone().index_add_(axis, idx, src)
def _segment_sum(src, seg, n):
    out = torch.zeros((n,) + src.shape[1:], dtype=src.dtype)
    return out.index_add_(0, seg, src)
def _pad(x, pw):
    flat = tuple(v for pair in reversed(pw) for v in pair)
    return torch.nn.functional.pad(x, flat)

kernel_name = 'standalone__fused_io_aware_attn__prompt'

def setup_inputs():

    _w = (lambda a: (lambda t: t.to(torch.bfloat16) if t.is_floating_point() else t)(torch.as_tensor(a)))
    B, H, S = 1, 32, 2048
    Dh = max(1, 576 // 32)
    return {
        "q": _w((lambda *s: torch.randn(*s, dtype=torch.bfloat16) * 0.8)(B, H, S, Dh)),
        "k": _w((lambda *s: torch.randn(*s, dtype=torch.bfloat16) * 0.8)(B, H, S, Dh)),
        "v": _w((lambda *s: torch.randn(*s, dtype=torch.bfloat16) * 0.05)(B, H, S, Dh)),
    }

def reference(q, k, v):
    scale = q.shape[-1] ** -0.5
    s = torch.einsum('bhqd,bhkd->bhqk', q, k) * scale
    p = _softmax(s, axis=-1)
    return torch.einsum('bhqk,bhkd->bhqd', p, v)
```

```asm
; @launch grid=(256,1,1) block=(512,1,1) lds=160896
.amdgcn_target "amdgcn-amd-amdhsa--gfx950"
.text
.globl standalone__fused_io_aware_attn__prompt_kernel
.p2align 8
.type standalone__fused_io_aware_attn__prompt_kernel,@function
standalone__fused_io_aware_attn__prompt_kernel:
    s_cmp_ge_u32 s2, 0x100
    s_cbranch_scc1 L_end
    s_load_dwordx2 s[16:17], s[0:1], 0
    s_load_dwordx2 s[20:21], s[0:1], 8
    s_load_dwordx2 s[24:25], s[0:1], 16
    s_load_dwordx2 s[28:29], s[0:1], 24
    v_lshrrev_b32 v22, 6, v0
    v_and_b32 v1, 63, v0
    v_readfirstlane_b32 s3, v22
    s_and_b32 s12, s2, 7
    s_lshr_b32 s8, s2, 6
    v_lshlrev_b32 v3, 4, v1
    s_lshl2_add_u32 s12, s12, s8
    s_bfe_u32 s13, s2, 0x30003
    v_and_b32 v20, 31, v1
    s_mul_i32 s12, s12, 73728
    s_lshl_b32 s32, s3, 10
    v_lshrrev_b32 v21, 5, v1
    s_cmp_lt_u32 s3, 5
    s_cselect_b32 s8, 0, -5120
    s_cselect_b32 s9, 0, 68608
    s_add_u32 s34, s32, s12
    v_mul_u32_u24 v22, 36, v20
    s_add_u32 m0, s32, s9
    s_add_u32 s4, s34, s8
    v_lshlrev_b32 v24, 4, v21
    s_mov_b32 s54, 2359296
    s_mov_b32 s55, 0x20000
    v_add_u32 v2, v24, v22
    s_mul_i32 s13, s13, 9216
    s_mul_i32 s9, s3, 1152
    s_mov_b32 s18, 2359296
    s_add_u32 s33, s13, s9
    s_mov_b32 s19, 0x20000
    s_add_u32 s33, s33, s12
    s_cmp_lt_u32 s3, 5
    s_waitcnt lgkmcnt(0)
    s_cselect_b32 s52, s20, s24
    s_cselect_b32 s53, s21, s25
    buffer_load_dwordx4 v3, s[52:55], s4 offen nt lds
    s_barrier
    buffer_load_dwordx4 v[176:179], v2, s[16:19], s33 offen nt
    buffer_load_dword v180, v2, s[16:19], s33 offen offset:16 nt
    s_cmp_lt_u32 s3, 3
    s_cselect_b32 s8, 5120, 0
    s_cselect_b32 s9, s8, 73728
    s_cselect_b32 s56, s20, s24
    s_cselect_b32 s57, s21, s25
    s_mov_b32 s58, 2359296
    s_add_u32 m0, s32, s9
    s_mov_b32 s59, 0x20000
    s_add_u32 s5, s34, s8
    buffer_load_dwordx4 v3, s[56:59], s5 offen nt lds
    s_mov_b32 s22, 2359296
    s_mov_b32 s23, 0x20000
    s_mov_b32 s26, 2359296
    s_mov_b32 s27, 0x20000
    s_mov_b32 s30, 2359296
    s_mov_b32 s31, 0x20000
    s_mul_i32 s8, s3, 1168
    s_add_u32 s8, s8, 151552
    v_mul_u32_u24 v208, 36, v20
    v_lshl_add_u32 v208, v21, 3, v208
    v_add_u32 v208, s8, v208
    v_add_u32 v209, s8, v3
    v_min_u32 v210, 0x70, v3
    v_add_u32 v210, s8, v210
    v_mul_u32_u24 v22, 72, v20
    v_add_u32 v4, v24, v22
    v_lshlrev_b32 v23, 2, v21
    v_sub_u32 v23, v22, v23
    v_add_u32 v6, 36, v23
    v_add_u32 v5, 36864, v4
    v_add_u32 v7, 36864, v6
    s_add_u32 s35, s34, 8192
    s_add_u32 s36, s34, 16384
    s_add_u32 s37, s34, 24576
    s_add_u32 s38, s34, 32768
    s_add_u32 s39, s34, 40960
    s_add_u32 s40, s34, 49152
    s_add_u32 s41, s34, 57344
    s_add_u32 s42, s34, 65536
    v_bfe_u32 v20, v1, 2, 2
    v_mul_u32_u24 v20, 72, v20
    v_mul_u32_u24 v22, 576, v21
    v_and_b32 v26, 3, v1
    v_bfe_u32 v23, v1, 4, 1
    v_add_u32 v20, v20, v22
    v_lshl_add_u32 v26, v23, 2, v26
    v_lshl_add_u32 v20, v26, 3, v20
    v_add_u32 v20, 73728, v20
    v_lshlrev_b32 v25, 6, v21
    v_cmp_eq_u32 vcc, 5, v26
    v_add_u32 v27, 147504, v25
    v_add_u32 v25, 147496, v25
    v_cndmask_b32 v25, v27, v25, vcc
    v_cmp_lt_u32 vcc, 4, v26
    v_mov_b32 v28, 0x3f80
    v_mov_b32 v29, 0
    v_cndmask_b32 v8, v20, v25, vcc
    v_mov_b32 v22, 4608
    v_cndmask_b32 v22, v22, v29, vcc
    v_mov_b32 v30, 0
    v_mov_b32 v31, 0
    v_add_u32 v9, v8, v22
    v_add_u32 v10, v9, v22
    v_add_u32 v11, v10, v22
    v_add_u32 v12, v11, v22
    v_add_u32 v13, v12, v22
    v_add_u32 v14, v13, v22
    v_add_u32 v15, v14, v22
    v_add_u32 v200, v15, v22
    v_add_u32 v201, v200, v22
    v_add_u32 v202, v201, v22
    v_add_u32 v203, v202, v22
    v_add_u32 v204, v203, v22
    v_add_u32 v205, v204, v22
    v_add_u32 v206, v205, v22
    v_add_u32 v207, v206, v22
    v_add_u32 v25, s32, v3
    v_add_u32 v25, 147456, v25
    ds_write_b128 v25, v[28:31]
    v_mov_b32 v16, 0xdddddddd
    v_mov_b32 v145, 0x3f803f80
    v_mov_b32 v147, 0x3f803f80
    v_mfma_f32_32x32x4_2b_bf16 v[96:127], v[30:31], v[30:31], 0
    s_mov_b32 s45, 0x3eae1a93
    s_mov_b32 s46, 0xffff0000
    s_mov_b32 s6, 0
    s_mov_b32 s7, -1
    s_cmp_ge_u32 s3, 4
    s_cselect_b64 vcc, -1, 0
    s_add_u32 m0, s32, 8192
    s_nop 0
    buffer_load_dwordx4 v3, s[20:23], s35 offen nt lds
    s_add_u32 m0, s32, 81920
    s_nop 0
    buffer_load_dwordx4 v3, s[24:27], s35 offen nt lds
    s_waitcnt vmcnt(5)
    s_waitcnt lgkmcnt(0)
    s_barrier
    ds_read_b128 v[184:187], v24 offset:0
    ds_read_b32 v188, v24 offset:16
    ds_read_b32 v144, v6 offset:0
    ds_read_b64 v[128:129], v4 offset:40
    ds_read_b64 v[130:131], v4 offset:48
    ds_read_b64 v[132:133], v4 offset:0
    ds_read_b64 v[134:135], v4 offset:8
    ds_read_b32 v146, v6 offset:2304
    ds_read_b64 v[136:137], v4 offset:2344
    ds_read_b64 v[138:139], v4 offset:2352
    ds_read_b64 v[140:141], v4 offset:2304
    ds_read_b64 v[142:143], v4 offset:2312
    s_waitcnt lgkmcnt(7)
    ds_read_b64_tr_b16 v[160:161], v8 offset:32
    ds_read_b64_tr_b16 v[162:163], v8 offset:320
    ds_read_b64_tr_b16 v[164:165], v8 offset:1184
    ds_read_b64_tr_b16 v[166:167], v8 offset:1472
    ds_read_b64_tr_b16 v[168:169], v8 offset:0
    ds_read_b64_tr_b16 v[170:171], v8 offset:288
    ds_read_b64_tr_b16 v[172:173], v8 offset:1152
    ds_read_b64_tr_b16 v[174:175], v8 offset:1440
    v_cndmask_b32 v188, 0, v188, s[6:7]
    s_waitcnt vmcnt(4)
    v_dot2_f32_bf16 v20, v176, v184, 0
    v_dot2_f32_bf16 v21, v177, v185, 0
    v_lshlrev_b32 v22, 16, v176
    v_and_b32 v23, s46, v176
    v_dot2_f32_bf16 v20, v178, v186, v20
    v_dot2_f32_bf16 v21, v179, v187, v21
    v_mul_f32 v22, s45, v22
    v_mul_f32 v23, s45, v23
    s_waitcnt vmcnt(3)
    v_lshlrev_b32 v28, 16, v180
    v_dot2_f32_bf16 v20, v180, v188, v20
    v_and_b32 v29, s46, v180
    v_cvt_pk_bf16_f32 v152, v22, v23
    v_mul_f32 v28, s45, v28
    v_mul_f32 v29, s45, v29
    v_add_f32 v20, v20, v21
    v_cvt_pk_bf16_f32 v151, v28, v29
    v_mov_b32 v21, v20
    v_cndmask_b32 v156, v152, v151, s[6:7]
    v_lshlrev_b32 v26, 16, v177
    v_permlane32_swap_b32 v20, v21
    v_and_b32 v27, s46, v177
    v_mul_f32 v26, s45, v26
    v_add_f32 v20, v20, v21
    v_mul_f32 v27, s45, v27
    v_mul_f32 v20, s45, v20
    v_cvt_pk_bf16_f32 v153, v26, v27
    v_cvt_pk_bf16_f32 v157, -v20, 0
    v_cvt_pk_bf16_f32 v148, v26, v27
    v_lshlrev_b32 v22, 16, v178
    v_mfma_f32_32x32x4_2b_bf16 v[32:63], v[144:145], v[156:157], 0
    v_and_b32 v23, s46, v178
    v_mul_f32 v22, s45, v22
    v_mul_f32 v23, s45, v23
    v_cvt_pk_bf16_f32 v154, v22, v23
    v_cvt_pk_bf16_f32 v149, v22, v23
    v_lshlrev_b32 v26, 16, v179
    v_and_b32 v27, s46, v179
    v_mul_f32 v26, s45, v26
    v_mul_f32 v27, s45, v27
    v_cvt_pk_bf16_f32 v155, v26, v27
    v_cvt_pk_bf16_f32 v150, v26, v27
    s_nop 6
    v_mfma_f32_32x32x16_bf16 v[32:47], v[128:131], v[148:151], v[32:47]
    s_waitcnt lgkmcnt(13)
    v_mfma_f32_32x32x16_bf16 v[48:63], v[132:135], v[152:155], v[48:63]
    s_cbranch_vccz L_cb1
    s_waitcnt vmcnt(2)
    s_barrier
L_cb1:
    s_setprio 3
    s_nop 7
    v_exp_f32 v32, v32
    v_exp_f32 v33, v33
    v_exp_f32 v34, v34
    v_exp_f32 v35, v35
    s_waitcnt lgkmcnt(12)
    v_mfma_f32_32x32x4_2b_bf16 v[64:95], v[146:147], v[156:157], 0
    v_exp_f32 v36, v36
    v_exp_f32 v37, v37
    v_exp_f32 v38, v38
    v_exp_f32 v39, v39
    v_exp_f32 v40, v40
    v_exp_f32 v41, v41
    v_exp_f32 v42, v42
    v_exp_f32 v43, v43
    s_waitcnt lgkmcnt(6)
    v_smfmac_f32_32x32x32_bf16 v[96:111], v[160:163], v[32:39], v16
    v_exp_f32 v44, v44
    v_exp_f32 v45, v45
    v_exp_f32 v46, v46
    v_exp_f32 v47, v47
    s_cbranch_vccnz L_cb2
    s_waitcnt vmcnt(2)
    s_barrier
L_cb2:
    ds_read_b32 v144, v6 offset:4608
    ds_read_b64_tr_b16 v[176:177], v8 offset:2336
    v_exp_f32 v48, v48
    v_exp_f32 v49, v49
    s_waitcnt lgkmcnt(6)
    v_smfmac_f32_32x32x32_bf16 v[96:111], v[164:167], v[40:47], v16
    ds_read_b64_tr_b16 v[178:179], v8 offset:2624
    ds_read_b64_tr_b16 v[180:181], v8 offset:3488
    v_exp_f32 v50, v50
    v_exp_f32 v51, v51
    ds_read_b64_tr_b16 v[182:183], v8 offset:3776
    v_exp_f32 v52, v52
    v_exp_f32 v53, v53
    v_mfma_f32_32x32x16_bf16 v[64:79], v[136:139], v[148:151], v[64:79]
    ds_read_b64 v[128:129], v4 offset:4648
    ds_read_b64 v[130:131], v4 offset:4656
    s_add_u32 m0, s32, 16384
    v_exp_f32 v54, v54
    buffer_load_dwordx4 v3, s[20:23], s36 offen lds
    v_exp_f32 v55, v55
    ds_read_b64 v[132:133], v4 offset:4608
    ds_read_b64 v[134:135], v4 offset:4616
    v_exp_f32 v56, v56
    v_exp_f32 v57, v57
    v_mfma_f32_32x32x16_bf16 v[80:95], v[140:143], v[152:155], v[80:95]
    ds_read_b64_tr_b16 v[184:185], v8 offset:2304
    ds_read_b64_tr_b16 v[186:187], v8 offset:2592
    s_add_u32 m0, s32, 90112
    v_exp_f32 v58, v58
    buffer_load_dwordx4 v3, s[24:27], s36 offen lds
    v_exp_f32 v59, v59
    v_exp_f32 v60, v60
    s_waitcnt lgkmcnt(13)
    v_smfmac_f32_32x32x32_bf16 v[112:127], v[168:171], v[48:55], v16
    ds_read_b64_tr_b16 v[188:189], v8 offset:3456
    ds_read_b64_tr_b16 v[190:191], v8 offset:3744
    v_exp_f32 v61, v61
    v_exp_f32 v62, v62
    v_exp_f32 v63, v63
    s_setprio 2
    v_exp_f32 v64, v64
    v_exp_f32 v65, v65
    s_waitcnt lgkmcnt(13)
    v_smfmac_f32_32x32x32_bf16 v[112:127], v[172:175], v[56:63], v16
    s_cbranch_vccz L_cb3
    s_waitcnt vmcnt(2)
    s_barrier
L_cb3:
    ds_read_b64_tr_b16 v[160:161], v9 offset:32
    v_exp_f32 v66, v66
    v_exp_f32 v67, v67
    s_waitcnt lgkmcnt(13)
    v_mfma_f32_32x32x4_2b_bf16 v[32:63], v[144:145], v[156:157], 0
    ds_read_b64_tr_b16 v[162:163], v9 offset:320
    ds_read_b64_tr_b16 v[164:165], v9 offset:1184
    s_waitcnt lgkmcnt(2)
    v_exp_f32 v68, v68
    v_exp_f32 v69, v69
    v_exp_f32 v70, v70
    v_exp_f32 v71, v71
    v_exp_f32 v72, v72
    v_exp_f32 v73, v73
    v_exp_f32 v74, v74
    v_exp_f32 v75, v75
    v_smfmac_f32_32x32x32_bf16 v[96:111], v[176:179], v[64:71], v16
    ds_read_b64_tr_b16 v[166:167], v9 offset:1472
    v_exp_f32 v76, v76
    v_exp_f32 v77, v77
    v_exp_f32 v78, v78
    v_exp_f32 v79, v79
    s_cbranch_vccnz L_cb4
    s_waitcnt vmcnt(2)
    s_barrier
L_cb4:
    ds_read_b32 v146, v6 offset:6912
    ds_read_b64 v[136:137], v4 offset:6952
    v_exp_f32 v80, v80
    v_exp_f32 v81, v81
    v_smfmac_f32_32x32x32_bf16 v[96:111], v[180:183], v[72:79], v16
    ds_read_b64 v[138:139], v4 offset:6960
    ds_read_b64 v[140:141], v4 offset:6912
    v_exp_f32 v82, v82
    v_exp_f32 v83, v83
    v_exp_f32 v84, v84
    v_exp_f32 v85, v85
    v_mfma_f32_32x32x16_bf16 v[32:47], v[128:131], v[148:151], v[32:47]
    ds_read_b64 v[142:143], v4 offset:6920
    ds_read_b64_tr_b16 v[168:169], v9 offset:0
    s_add_u32 m0, s32, 24576
    v_exp_f32 v86, v86
    buffer_load_dwordx4 v3, s[20:23], s37 offen lds
    v_exp_f32 v87, v87
    v_exp_f32 v88, v88
    v_exp_f32 v89, v89
    v_mfma_f32_32x32x16_bf16 v[48:63], v[132:135], v[152:155], v[48:63]
    ds_read_b64_tr_b16 v[170:171], v9 offset:288
    ds_read_b64_tr_b16 v[172:173], v9 offset:1152
    s_add_u32 m0, s32, 98304
    v_exp_f32 v90, v90
    buffer_load_dwordx4 v3, s[24:27], s37 offen lds
    v_exp_f32 v91, v91
    v_exp_f32 v92, v92
    v_smfmac_f32_32x32x32_bf16 v[112:127], v[184:187], v[80:87], v16
    ds_read_b64_tr_b16 v[174:175], v9 offset:1440
    v_exp_f32 v93, v93
    v_exp_f32 v94, v94
    v_exp_f32 v95, v95
    s_setprio 1
    v_exp_f32 v32, v32
    v_exp_f32 v33, v33
    v_smfmac_f32_32x32x32_bf16 v[112:127], v[188:191], v[88:95], v16
    ds_read_b32 v144, v6 offset:9216
    ds_read_b64_tr_b16 v[176:177], v9 offset:2336
    v_exp_f32 v34, v34
    v_exp_f32 v35, v35
    s_waitcnt lgkmcnt(10)
    v_mfma_f32_32x32x4_2b_bf16 v[64:95], v[146:147], v[156:157], 0
    ds_read_b64_tr_b16 v[178:179], v9 offset:2624
    ds_read_b64_tr_b16 v[180:181], v9 offset:3488
    s_waitcnt lgkmcnt(2)
    v_exp_f32 v36, v36
    v_exp_f32 v37, v37
    v_exp_f32 v38, v38
    v_exp_f32 v39, v39
    v_exp_f32 v40, v40
    v_exp_f32 v41, v41
    v_exp_f32 v42, v42
    v_exp_f32 v43, v43
    v_smfmac_f32_32x32x32_bf16 v[96:111], v[160:163], v[32:39], v16
    ds_read_b64_tr_b16 v[182:183], v9 offset:3776
    ds_read_b64 v[128:129], v4 offset:9256
    v_exp_f32 v44, v44
    v_exp_f32 v45, v45
    v_exp_f32 v46, v46
    v_exp_f32 v47, v47
    v_exp_f32 v48, v48
    v_exp_f32 v49, v49
    v_smfmac_f32_32x32x32_bf16 v[96:111], v[164:167], v[40:47], v16
    ds_read_b64 v[130:131], v4 offset:9264
    ds_read_b64 v[132:133], v4 offset:9216
    v_exp_f32 v50, v50
    v_exp_f32 v51, v51
    v_exp_f32 v52, v52
    v_exp_f32 v53, v53
    v_mfma_f32_32x32x16_bf16 v[64:79], v[136:139], v[148:151], v[64:79]
    ds_read_b64 v[134:135], v4 offset:9224
    ds_read_b64_tr_b16 v[184:185], v9 offset:2304
    v_exp_f32 v54, v54
    v_exp_f32 v55, v55
    v_exp_f32 v56, v56
    v_exp_f32 v57, v57
    v_mfma_f32_32x32x16_bf16 v[80:95], v[140:143], v[152:155], v[80:95]
    ds_read_b64_tr_b16 v[186:187], v9 offset:2592
    ds_read_b64_tr_b16 v[188:189], v9 offset:3456
    v_exp_f32 v58, v58
    v_exp_f32 v59, v59
    v_exp_f32 v60, v60
    v_smfmac_f32_32x32x32_bf16 v[112:127], v[168:171], v[48:55], v16
    ds_read_b64_tr_b16 v[190:191], v9 offset:3744
    v_exp_f32 v61, v61
    v_exp_f32 v62, v62
    v_exp_f32 v63, v63
    s_setprio 0
    v_exp_f32 v64, v64
    v_exp_f32 v65, v65
    v_smfmac_f32_32x32x32_bf16 v[112:127], v[172:175], v[56:63], v16
    ds_read_b32 v146, v6 offset:11520
    ds_read_b64_tr_b16 v[160:161], v10 offset:32
    v_exp_f32 v66, v66
    v_exp_f32 v67, v67
    v_mfma_f32_32x32x4_2b_bf16 v[32:63], v[144:145], v[156:157], 0
    ds_read_b64_tr_b16 v[162:163], v10 offset:320
    ds_read_b64_tr_b16 v[164:165], v10 offset:1184
    s_waitcnt lgkmcnt(2)
    v_exp_f32 v68, v68
    v_exp_f32 v69, v69
    v_exp_f32 v70, v70
    v_exp_f32 v71, v71
    v_exp_f32 v72, v72
    v_exp_f32 v73, v73
    v_exp_f32 v74, v74
    v_exp_f32 v75, v75
    v_smfmac_f32_32x32x32_bf16 v[96:111], v[176:179], v[64:71], v16
    ds_read_b64_tr_b16 v[166:167], v10 offset:1472
    ds_read_b64 v[136:137], v4 offset:11560
    v_exp_f32 v76, v76
    v_exp_f32 v77, v77
    v_exp_f32 v78, v78
    v_exp_f32 v79, v79
    v_exp_f32 v80, v80
    v_exp_f32 v81, v81
    v_smfmac_f32_32x32x32_bf16 v[96:111], v[180:183], v[72:79], v16
    ds_read_b64 v[138:139], v4 offset:11568
    ds_read_b64 v[140:141], v4 offset:11520
    v_exp_f32 v82, v82
    v_exp_f32 v83, v83
    v_exp_f32 v84, v84
    v_exp_f32 v85, v85
    v_mfma_f32_32x32x16_bf16 v[32:47], v[128:131], v[148:151], v[32:47]
    ds_read_b64 v[142:143], v4 offset:11528
    ds_read_b64_tr_b16 v[168:169], v10 offset:0
    v_exp_f32 v86, v86
    v_exp_f32 v87, v87
    v_exp_f32 v88, v88
    v_exp_f32 v89, v89
    v_mfma_f32_32x32x16_bf16 v[48:63], v[132:135], v[152:155], v[48:63]
    ds_read_b64_tr_b16 v[170:171], v10 offset:288
    ds_read_b64_tr_b16 v[172:173], v10 offset:1152
    v_exp_f32 v90, v90
    v_exp_f32 v91, v91
    v_exp_f32 v92, v92
    v_smfmac_f32_32x32x32_bf16 v[112:127], v[184:187], v[80:87], v16
    ds_read_b64_tr_b16 v[174:175], v10 offset:1440
    v_exp_f32 v93, v93
    v_exp_f32 v94, v94
    v_exp_f32 v95, v95
    s_setprio 3
    s_waitcnt vmcnt(0)
    s_barrier
    v_exp_f32 v32, v32
    v_exp_f32 v33, v33
    v_smfmac_f32_32x32x32_bf16 v[112:127], v[188:191], v[88:95], v16
    ds_read_b32 v144, v6 offset:13824
    ds_read_b64_tr_b16 v[176:177], v10 offset:2336
    v_exp_f32 v34, v34
    v_exp_f32 v35, v35
    v_mfma_f32_32x32x4_2b_bf16 v[64:95], v[146:147], v[156:157], 0
    ds_read_b64_tr_b16 v[178:179], v10 offset:2624
    ds_read_b64_tr_b16 v[180:181], v10 offset:3488
    s_waitcnt lgkmcnt(2)
    v_exp_f32 v36, v36
    v_exp_f32 v37, v37
    v_exp_f32 v38, v38
    v_exp_f32 v39, v39
    v_exp_f32 v40, v40
    v_exp_f32 v41, v41
    v_exp_f32 v42, v42
    v_exp_f32 v43, v43
    v_smfmac_f32_32x32x32_bf16 v[96:111], v[160:163], v[32:39], v16
    ds_read_b64_tr_b16 v[182:183], v10 offset:3776
    ds_read_b64 v[128:129], v4 offset:13864
    v_exp_f32 v44, v44
    v_exp_f32 v45, v45
    v_exp_f32 v46, v46
    v_exp_f32 v47, v47
    v_exp_f32 v48, v48
    v_exp_f32 v49, v49
    v_smfmac_f32_32x32x32_bf16 v[96:111], v[164:167], v[40:47], v16
    ds_read_b64 v[130:131], v4 offset:13872
    ds_read_b64 v[132:133], v4 offset:13824
    v_exp_f32 v50, v50
    v_exp_f32 v51, v51
    v_exp_f32 v52, v52
    v_exp_f32 v53, v53
    v_mfma_f32_32x32x16_bf16 v[64:79], v[136:139], v[148:151], v[64:79]
    ds_read_b64 v[134:135], v4 offset:13832
    ds_read_b64_tr_b16 v[184:185], v10 offset:2304
    s_add_u32 m0, s32, 32768
    v_exp_f32 v54, v54
    buffer_load_dwordx4 v3, s[20:23], s38 offen lds
    v_exp_f32 v55, v55
    v_exp_f32 v56, v56
    v_exp_f32 v57, v57
    v_mfma_f32_32x32x16_bf16 v[80:95], v[140:143], v[152:155], v[80:95]
    ds_read_b64_tr_b16 v[186:187], v10 offset:2592
    ds_read_b64_tr_b16 v[188:189], v10 offset:3456
    s_add_u32 m0, s32, 106496
    v_exp_f32 v58, v58
    buffer_load_dwordx4 v3, s[24:27], s38 offen lds
    v_exp_f32 v59, v59
    v_exp_f32 v60, v60
    v_smfmac_f32_32x32x32_bf16 v[112:127], v[168:171], v[48:55], v16
    ds_read_b64_tr_b16 v[190:191], v10 offset:3744
    v_exp_f32 v61, v61
    v_exp_f32 v62, v62
    v_exp_f32 v63, v63
    s_setprio 2
    v_exp_f32 v64, v64
    v_exp_f32 v65, v65
    v_smfmac_f32_32x32x32_bf16 v[112:127], v[172:175], v[56:63], v16
    ds_read_b32 v146, v6 offset:16128
    ds_read_b64_tr_b16 v[160:161], v11 offset:32
    v_exp_f32 v66, v66
    v_exp_f32 v67, v67
    v_mfma_f32_32x32x4_2b_bf16 v[32:63], v[144:145], v[156:157], 0
    ds_read_b64_tr_b16 v[162:163], v11 offset:320
    ds_read_b64_tr_b16 v[164:165], v11 offset:1184
    s_waitcnt lgkmcnt(2)
    v_exp_f32 v68, v68
    v_exp_f32 v69, v69
    v_exp_f32 v70, v70
    v_exp_f32 v71, v71
    v_exp_f32 v72, v72
    v_exp_f32 v73, v73
    v_exp_f32 v74, v74
    v_exp_f32 v75, v75
    v_smfmac_f32_32x32x32_bf16 v[96:111], v[176:179], v[64:71], v16
    ds_read_b64_tr_b16 v[166:167], v11 offset:1472
    ds_read_b64 v[136:137], v4 offset:16168
    v_exp_f32 v76, v76
    v_exp_f32 v77, v77
    v_exp_f32 v78, v78
    v_exp_f32 v79, v79
    v_exp_f32 v80, v80
    v_exp_f32 v81, v81
    v_smfmac_f32_32x32x32_bf16 v[96:111], v[180:183], v[72:79], v16
    ds_read_b64 v[138:139], v4 offset:16176
    ds_read_b64 v[140:141], v4 offset:16128
    v_exp_f32 v82, v82
    v_exp_f32 v83, v83
    v_exp_f32 v84, v84
    v_exp_f32 v85, v85
    v_mfma_f32_32x32x16_bf16 v[32:47], v[128:131], v[148:151], v[32:47]
    ds_read_b64 v[142:143], v4 offset:16136
    ds_read_b64_tr_b16 v[168:169], v11 offset:0
    s_add_u32 m0, s32, 40960
    v_exp_f32 v86, v86
    buffer_load_dwordx4 v3, s[20:23], s39 offen lds
    v_exp_f32 v87, v87
    v_exp_f32 v88, v88
    v_exp_f32 v89, v89
    v_mfma_f32_32x32x16_bf16 v[48:63], v[132:135], v[152:155], v[48:63]
    ds_read_b64_tr_b16 v[170:171], v11 offset:288
    ds_read_b64_tr_b16 v[172:173], v11 offset:1152
    s_add_u32 m0, s32, 114688
    v_exp_f32 v90, v90
    buffer_load_dwordx4 v3, s[24:27], s39 offen lds
    v_exp_f32 v91, v91
    v_exp_f32 v92, v92
    v_smfmac_f32_32x32x32_bf16 v[112:127], v[184:187], v[80:87], v16
    ds_read_b64_tr_b16 v[174:175], v11 offset:1440
    v_exp_f32 v93, v93
    v_exp_f32 v94, v94
    v_exp_f32 v95, v95
    s_setprio 1
    v_exp_f32 v32, v32
    v_exp_f32 v33, v33
    v_smfmac_f32_32x32x32_bf16 v[112:127], v[188:191], v[88:95], v16
    ds_read_b32 v144, v6 offset:18432
    ds_read_b64_tr_b16 v[176:177], v11 offset:2336
    v_exp_f32 v34, v34
    v_exp_f32 v35, v35
    v_mfma_f32_32x32x4_2b_bf16 v[64:95], v[146:147], v[156:157], 0
    ds_read_b64_tr_b16 v[178:179], v11 offset:2624
    ds_read_b64_tr_b16 v[180:181], v11 offset:3488
    s_waitcnt lgkmcnt(2)
    v_exp_f32 v36, v36
    v_exp_f32 v37, v37
    v_exp_f32 v38, v38
    v_exp_f32 v39, v39
    v_exp_f32 v40, v40
    v_exp_f32 v41, v41
    v_exp_f32 v42, v42
    v_exp_f32 v43, v43
    v_smfmac_f32_32x32x32_bf16 v[96:111], v[160:163], v[32:39], v16
    ds_read_b64_tr_b16 v[182:183], v11 offset:3776
    ds_read_b64 v[128:129], v4 offset:18472
    v_exp_f32 v44, v44
    v_exp_f32 v45, v45
    v_exp_f32 v46, v46
    v_exp_f32 v47, v47
    v_exp_f32 v48, v48
    v_exp_f32 v49, v49
    v_smfmac_f32_32x32x32_bf16 v[96:111], v[164:167], v[40:47], v16
    ds_read_b64 v[130:131], v4 offset:18480
    ds_read_b64 v[132:133], v4 offset:18432
    v_exp_f32 v50, v50
    v_exp_f32 v51, v51
    v_exp_f32 v52, v52
    v_exp_f32 v53, v53
    v_mfma_f32_32x32x16_bf16 v[64:79], v[136:139], v[148:151], v[64:79]
    ds_read_b64 v[134:135], v4 offset:18440
    ds_read_b64_tr_b16 v[184:185], v11 offset:2304
    s_add_u32 m0, s32, 49152
    v_exp_f32 v54, v54
    buffer_load_dwordx4 v3, s[20:23], s40 offen lds
    v_exp_f32 v55, v55
    v_exp_f32 v56, v56
    v_exp_f32 v57, v57
    v_mfma_f32_32x32x16_bf16 v[80:95], v[140:143], v[152:155], v[80:95]
    ds_read_b64_tr_b16 v[186:187], v11 offset:2592
    ds_read_b64_tr_b16 v[188:189], v11 offset:3456
    s_add_u32 m0, s32, 122880
    v_exp_f32 v58, v58
    buffer_load_dwordx4 v3, s[24:27], s40 offen lds
    v_exp_f32 v59, v59
    v_exp_f32 v60, v60
    v_smfmac_f32_32x32x32_bf16 v[112:127], v[168:171], v[48:55], v16
    ds_read_b64_tr_b16 v[190:191], v11 offset:3744
    v_exp_f32 v61, v61
    v_exp_f32 v62, v62
    v_exp_f32 v63, v63
    s_setprio 0
    v_exp_f32 v64, v64
    v_exp_f32 v65, v65
    v_smfmac_f32_32x32x32_bf16 v[112:127], v[172:175], v[56:63], v16
    ds_read_b32 v146, v6 offset:20736
    ds_read_b64_tr_b16 v[160:161], v12 offset:32
    v_exp_f32 v66, v66
    v_exp_f32 v67, v67
    v_mfma_f32_32x32x4_2b_bf16 v[32:63], v[144:145], v[156:157], 0
    ds_read_b64_tr_b16 v[162:163], v12 offset:320
    ds_read_b64_tr_b16 v[164:165], v12 offset:1184
    s_waitcnt lgkmcnt(2)
    v_exp_f32 v68, v68
    v_exp_f32 v69, v69
    v_exp_f32 v70, v70
    v_exp_f32 v71, v71
    v_exp_f32 v72, v72
    v_exp_f32 v73, v73
    v_exp_f32 v74, v74
    v_exp_f32 v75, v75
    v_smfmac_f32_32x32x32_bf16 v[96:111], v[176:179], v[64:71], v16
    ds_read_b64_tr_b16 v[166:167], v12 offset:1472
    ds_read_b64 v[136:137], v4 offset:20776
    v_exp_f32 v76, v76
    v_exp_f32 v77, v77
    v_exp_f32 v78, v78
    v_exp_f32 v79, v79
    v_exp_f32 v80, v80
    v_exp_f32 v81, v81
    v_smfmac_f32_32x32x32_bf16 v[96:111], v[180:183], v[72:79], v16
    ds_read_b64 v[138:139], v4 offset:20784
    ds_read_b64 v[140:141], v4 offset:20736
    v_exp_f32 v82, v82
    v_exp_f32 v83, v83
    v_exp_f32 v84, v84
    v_exp_f32 v85, v85
    v_mfma_f32_32x32x16_bf16 v[32:47], v[128:131], v[148:151], v[32:47]
    ds_read_b64 v[142:143], v4 offset:20744
    ds_read_b64_tr_b16 v[168:169], v12 offset:0
    s_add_u32 m0, s32, 57344
    v_exp_f32 v86, v86
    buffer_load_dwordx4 v3, s[20:23], s41 offen lds
    v_exp_f32 v87, v87
    v_exp_f32 v88, v88
    v_exp_f32 v89, v89
    v_mfma_f32_32x32x16_bf16 v[48:63], v[132:135], v[152:155], v[48:63]
    ds_read_b64_tr_b16 v[170:171], v12 offset:288
    ds_read_b64_tr_b16 v[172:173], v12 offset:1152
    s_add_u32 m0, s32, 131072
    v_exp_f32 v90, v90
    buffer_load_dwordx4 v3, s[24:27], s41 offen lds
    v_exp_f32 v91, v91
    v_exp_f32 v92, v92
    v_smfmac_f32_32x32x32_bf16 v[112:127], v[184:187], v[80:87], v16
    ds_read_b64_tr_b16 v[174:175], v12 offset:1440
    v_exp_f32 v93, v93
    v_exp_f32 v94, v94
    v_exp_f32 v95, v95
    s_setprio 3
    v_exp_f32 v32, v32
    v_exp_f32 v33, v33
    v_smfmac_f32_32x32x32_bf16 v[112:127], v[188:191], v[88:95], v16
    ds_read_b32 v144, v6 offset:23040
    ds_read_b64_tr_b16 v[176:177], v12 offset:2336
    v_exp_f32 v34, v34
    v_exp_f32 v35, v35
    v_mfma_f32_32x32x4_2b_bf16 v[64:95], v[146:147], v[156:157], 0
    ds_read_b64_tr_b16 v[178:179], v12 offset:2624
    ds_read_b64_tr_b16 v[180:181], v12 offset:3488
    s_waitcnt lgkmcnt(2)
    v_exp_f32 v36, v36
    v_exp_f32 v37, v37
    v_exp_f32 v38, v38
    v_exp_f32 v39, v39
    v_exp_f32 v40, v40
    v_exp_f32 v41, v41
    v_exp_f32 v42, v42
    v_exp_f32 v43, v43
    v_smfmac_f32_32x32x32_bf16 v[96:111], v[160:163], v[32:39], v16
    ds_read_b64_tr_b16 v[182:183], v12 offset:3776
    ds_read_b64 v[128:129], v4 offset:23080
    v_exp_f32 v44, v44
    v_exp_f32 v45, v45
    v_exp_f32 v46, v46
    v_exp_f32 v47, v47
    v_exp_f32 v48, v48
    v_exp_f32 v49, v49
    v_smfmac_f32_32x32x32_bf16 v[96:111], v[164:167], v[40:47], v16
    ds_read_b64 v[130:131], v4 offset:23088
    ds_read_b64 v[132:133], v4 offset:23040
    v_exp_f32 v50, v50
    v_exp_f32 v51, v51
    v_exp_f32 v52, v52
    v_exp_f32 v53, v53
    v_mfma_f32_32x32x16_bf16 v[64:79], v[136:139], v[148:151], v[64:79]
    ds_read_b64 v[134:135], v4 offset:23048
    ds_read_b64_tr_b16 v[184:185], v12 offset:2304
    s_add_u32 m0, s32, 65536
    v_exp_f32 v54, v54
    buffer_load_dwordx4 v3, s[20:23], s42 offen lds
    v_exp_f32 v55, v55
    v_exp_f32 v56, v56
    v_exp_f32 v57, v57
    v_mfma_f32_32x32x16_bf16 v[80:95], v[140:143], v[152:155], v[80:95]
    ds_read_b64_tr_b16 v[186:187], v12 offset:2592
    ds_read_b64_tr_b16 v[188:189], v12 offset:3456
    s_add_u32 m0, s32, 139264
    v_exp_f32 v58, v58
    buffer_load_dwordx4 v3, s[24:27], s42 offen lds
    v_exp_f32 v59, v59
    v_exp_f32 v60, v60
    v_smfmac_f32_32x32x32_bf16 v[112:127], v[168:171], v[48:55], v16
    ds_read_b64_tr_b16 v[190:191], v12 offset:3744
    v_exp_f32 v61, v61
    v_exp_f32 v62, v62
    v_exp_f32 v63, v63
    s_setprio 2
    v_exp_f32 v64, v64
    v_exp_f32 v65, v65
    v_smfmac_f32_32x32x32_bf16 v[112:127], v[172:175], v[56:63], v16
    ds_read_b32 v146, v6 offset:25344
    ds_read_b64_tr_b16 v[160:161], v13 offset:32
    v_exp_f32 v66, v66
    v_exp_f32 v67, v67
    v_mfma_f32_32x32x4_2b_bf16 v[32:63], v[144:145], v[156:157], 0
    ds_read_b64_tr_b16 v[162:163], v13 offset:320
    ds_read_b64_tr_b16 v[164:165], v13 offset:1184
    s_waitcnt lgkmcnt(2)
    v_exp_f32 v68, v68
    v_exp_f32 v69, v69
    v_exp_f32 v70, v70
    v_exp_f32 v71, v71
    v_exp_f32 v72, v72
    v_exp_f32 v73, v73
    v_exp_f32 v74, v74
    v_exp_f32 v75, v75
    v_smfmac_f32_32x32x32_bf16 v[96:111], v[176:179], v[64:71], v16
    ds_read_b64_tr_b16 v[166:167], v13 offset:1472
    ds_read_b64 v[136:137], v4 offset:25384
    v_exp_f32 v76, v76
    v_exp_f32 v77, v77
    v_exp_f32 v78, v78
    v_exp_f32 v79, v79
    v_exp_f32 v80, v80
    v_exp_f32 v81, v81
    v_smfmac_f32_32x32x32_bf16 v[96:111], v[180:183], v[72:79], v16
    ds_read_b64 v[138:139], v4 offset:25392
    ds_read_b64 v[140:141], v4 offset:25344
    v_exp_f32 v82, v82
    v_exp_f32 v83, v83
    v_exp_f32 v84, v84
    v_exp_f32 v85, v85
    v_mfma_f32_32x32x16_bf16 v[32:47], v[128:131], v[148:151], v[32:47]
    ds_read_b64 v[142:143], v4 offset:25352
    ds_read_b64_tr_b16 v[168:169], v13 offset:0
    v_exp_f32 v86, v86
    v_exp_f32 v87, v87
    v_exp_f32 v88, v88
    v_exp_f32 v89, v89
    v_mfma_f32_32x32x16_bf16 v[48:63], v[132:135], v[152:155], v[48:63]
    ds_read_b64_tr_b16 v[170:171], v13 offset:288
    ds_read_b64_tr_b16 v[172:173], v13 offset:1152
    v_exp_f32 v90, v90
    v_exp_f32 v91, v91
    v_exp_f32 v92, v92
    v_smfmac_f32_32x32x32_bf16 v[112:127], v[184:187], v[80:87], v16
    ds_read_b64_tr_b16 v[174:175], v13 offset:1440
    v_exp_f32 v93, v93
    v_exp_f32 v94, v94
    v_exp_f32 v95, v95
    s_setprio 1
    v_exp_f32 v32, v32
    v_exp_f32 v33, v33
    v_smfmac_f32_32x32x32_bf16 v[112:127], v[188:191], v[88:95], v16
    ds_read_b32 v144, v6 offset:27648
    ds_read_b64_tr_b16 v[176:177], v13 offset:2336
    v_exp_f32 v34, v34
    v_exp_f32 v35, v35
    v_mfma_f32_32x32x4_2b_bf16 v[64:95], v[146:147], v[156:157], 0
    ds_read_b64_tr_b16 v[178:179], v13 offset:2624
    ds_read_b64_tr_b16 v[180:181], v13 offset:3488
    s_waitcnt lgkmcnt(2)
    v_exp_f32 v36, v36
    v_exp_f32 v37, v37
    v_exp_f32 v38, v38
    v_exp_f32 v39, v39
    v_exp_f32 v40, v40
    v_exp_f32 v41, v41
    v_exp_f32 v42, v42
    v_exp_f32 v43, v43
    v_smfmac_f32_32x32x32_bf16 v[96:111], v[160:163], v[32:39], v16
    ds_read_b64_tr_b16 v[182:183], v13 offset:3776
    ds_read_b64 v[128:129], v4 offset:27688
    v_exp_f32 v44, v44
    v_exp_f32 v45, v45
    v_exp_f32 v46, v46
    v_exp_f32 v47, v47
    v_exp_f32 v48, v48
    v_exp_f32 v49, v49
    v_smfmac_f32_32x32x32_bf16 v[96:111], v[164:167], v[40:47], v16
    ds_read_b64 v[130:131], v4 offset:27696
    ds_read_b64 v[132:133], v4 offset:27648
    v_exp_f32 v50, v50
    v_exp_f32 v51, v51
    v_exp_f32 v52, v52
    v_exp_f32 v53, v53
    v_mfma_f32_32x32x16_bf16 v[64:79], v[136:139], v[148:151], v[64:79]
    ds_read_b64 v[134:135], v4 offset:27656
    ds_read_b64_tr_b16 v[184:185], v13 offset:2304
    v_exp_f32 v54, v54
    v_exp_f32 v55, v55
    v_exp_f32 v56, v56
    v_exp_f32 v57, v57
    v_mfma_f32_32x32x16_bf16 v[80:95], v[140:143], v[152:155], v[80:95]
    ds_read_b64_tr_b16 v[186:187], v13 offset:2592
    ds_read_b64_tr_b16 v[188:189], v13 offset:3456
    v_exp_f32 v58, v58
    v_exp_f32 v59, v59
    v_exp_f32 v60, v60
    v_smfmac_f32_32x32x32_bf16 v[112:127], v[168:171], v[48:55], v16
    ds_read_b64_tr_b16 v[190:191], v13 offset:3744
    v_exp_f32 v61, v61
    v_exp_f32 v62, v62
    v_exp_f32 v63, v63
    s_setprio 0
    v_exp_f32 v64, v64
    v_exp_f32 v65, v65
    v_smfmac_f32_32x32x32_bf16 v[112:127], v[172:175], v[56:63], v16
    ds_read_b32 v146, v6 offset:29952
    ds_read_b64_tr_b16 v[160:161], v14 offset:32
    v_exp_f32 v66, v66
    v_exp_f32 v67, v67
    v_mfma_f32_32x32x4_2b_bf16 v[32:63], v[144:145], v[156:157], 0
    ds_read_b64_tr_b16 v[162:163], v14 offset:320
    ds_read_b64_tr_b16 v[164:165], v14 offset:1184
    s_waitcnt lgkmcnt(2)
    v_exp_f32 v68, v68
    v_exp_f32 v69, v69
    v_exp_f32 v70, v70
    v_exp_f32 v71, v71
    v_exp_f32 v72, v72
    v_exp_f32 v73, v73
    v_exp_f32 v74, v74
    v_exp_f32 v75, v75
    v_smfmac_f32_32x32x32_bf16 v[96:111], v[176:179], v[64:71], v16
    ds_read_b64_tr_b16 v[166:167], v14 offset:1472
    ds_read_b64 v[136:137], v4 offset:29992
    v_exp_f32 v76, v76
    v_exp_f32 v77, v77
    v_exp_f32 v78, v78
    v_exp_f32 v79, v79
    v_exp_f32 v80, v80
    v_exp_f32 v81, v81
    v_smfmac_f32_32x32x32_bf16 v[96:111], v[180:183], v[72:79], v16
    ds_read_b64 v[138:139], v4 offset:30000
    ds_read_b64 v[140:141], v4 offset:29952
    v_exp_f32 v82, v82
    v_exp_f32 v83, v83
    v_exp_f32 v84, v84
    v_exp_f32 v85, v85
    v_mfma_f32_32x32x16_bf16 v[32:47], v[128:131], v[148:151], v[32:47]
    ds_read_b64 v[142:143], v4 offset:29960
    ds_read_b64_tr_b16 v[168:169], v14 offset:0
    v_exp_f32 v86, v86
    v_exp_f32 v87, v87
    v_exp_f32 v88, v88
    v_exp_f32 v89, v89
    v_mfma_f32_32x32x16_bf16 v[48:63], v[132:135], v[152:155], v[48:63]
    ds_read_b64_tr_b16 v[170:171], v14 offset:288
    ds_read_b64_tr_b16 v[172:173], v14 offset:1152
    v_exp_f32 v90, v90
    v_exp_f32 v91, v91
    v_exp_f32 v92, v92
    v_smfmac_f32_32x32x32_bf16 v[112:127], v[184:187], v[80:87], v16
    ds_read_b64_tr_b16 v[174:175], v14 offset:1440
    v_exp_f32 v93, v93
    v_exp_f32 v94, v94
    v_exp_f32 v95, v95
    s_setprio 3
    s_waitcnt vmcnt(0)
    s_barrier
    v_exp_f32 v32, v32
    v_exp_f32 v33, v33
    v_smfmac_f32_32x32x32_bf16 v[112:127], v[188:191], v[88:95], v16
    ds_read_b32 v144, v6 offset:32256
    ds_read_b64_tr_b16 v[176:177], v14 offset:2336
    v_exp_f32 v34, v34
    v_exp_f32 v35, v35
    v_mfma_f32_32x32x4_2b_bf16 v[64:95], v[146:147], v[156:157], 0
    ds_read_b64_tr_b16 v[178:179], v14 offset:2624
    ds_read_b64_tr_b16 v[180:181], v14 offset:3488
    s_waitcnt lgkmcnt(2)
    v_exp_f32 v36, v36
    v_exp_f32 v37, v37
    v_exp_f32 v38, v38
    v_exp_f32 v39, v39
    v_exp_f32 v40, v40
    v_exp_f32 v41, v41
    v_exp_f32 v42, v42
    v_exp_f32 v43, v43
    v_smfmac_f32_32x32x32_bf16 v[96:111], v[160:163], v[32:39], v16
    ds_read_b64_tr_b16 v[182:183], v14 offset:3776
    ds_read_b64 v[128:129], v4 offset:32296
    v_exp_f32 v44, v44
    v_exp_f32 v45, v45
    v_exp_f32 v46, v46
    v_exp_f32 v47, v47
    v_exp_f32 v48, v48
    v_exp_f32 v49, v49
    v_smfmac_f32_32x32x32_bf16 v[96:111], v[164:167], v[40:47], v16
    ds_read_b64 v[130:131], v4 offset:32304
    ds_read_b64 v[132:133], v4 offset:32256
    v_exp_f32 v50, v50
    v_exp_f32 v51, v51
    v_exp_f32 v52, v52
    v_exp_f32 v53, v53
    v_mfma_f32_32x32x16_bf16 v[64:79], v[136:139], v[148:151], v[64:79]
    ds_read_b64 v[134:135], v4 offset:32264
    ds_read_b64_tr_b16 v[184:185], v14 offset:2304
    v_exp_f32 v54, v54
    v_exp_f32 v55, v55
    v_exp_f32 v56, v56
    v_exp_f32 v57, v57
    v_mfma_f32_32x32x16_bf16 v[80:95], v[140:143], v[152:155], v[80:95]
    ds_read_b64_tr_b16 v[186:187], v14 offset:2592
    ds_read_b64_tr_b16 v[188:189], v14 offset:3456
    v_exp_f32 v58, v58
    v_exp_f32 v59, v59
    v_exp_f32 v60, v60
    v_smfmac_f32_32x32x32_bf16 v[112:127], v[168:171], v[48:55], v16
    ds_read_b64_tr_b16 v[190:191], v14 offset:3744
    v_exp_f32 v61, v61
    v_exp_f32 v62, v62
    v_exp_f32 v63, v63
    s_setprio 2
    v_exp_f32 v64, v64
    v_exp_f32 v65, v65
    v_smfmac_f32_32x32x32_bf16 v[112:127], v[172:175], v[56:63], v16
    ds_read_b32 v146, v6 offset:34560
    ds_read_b64_tr_b16 v[160:161], v15 offset:32
    v_exp_f32 v66, v66
    v_exp_f32 v67, v67
    v_mfma_f32_32x32x4_2b_bf16 v[32:63], v[144:145], v[156:157], 0
    ds_read_b64_tr_b16 v[162:163], v15 offset:320
    ds_read_b64_tr_b16 v[164:165], v15 offset:1184
    s_waitcnt lgkmcnt(2)
    v_exp_f32 v68, v68
    v_exp_f32 v69, v69
    v_exp_f32 v70, v70
    v_exp_f32 v71, v71
    v_exp_f32 v72, v72
    v_exp_f32 v73, v73
    v_exp_f32 v74, v74
    v_exp_f32 v75, v75
    v_smfmac_f32_32x32x32_bf16 v[96:111], v[176:179], v[64:71], v16
    ds_read_b64_tr_b16 v[166:167], v15 offset:1472
    ds_read_b64 v[136:137], v4 offset:34600
    v_exp_f32 v76, v76
    v_exp_f32 v77, v77
    v_exp_f32 v78, v78
    v_exp_f32 v79, v79
    v_exp_f32 v80, v80
    v_exp_f32 v81, v81
    v_smfmac_f32_32x32x32_bf16 v[96:111], v[180:183], v[72:79], v16
    ds_read_b64 v[138:139], v4 offset:34608
    ds_read_b64 v[140:141], v4 offset:34560
    v_exp_f32 v82, v82
    v_exp_f32 v83, v83
    v_exp_f32 v84, v84
    v_exp_f32 v85, v85
    v_mfma_f32_32x32x16_bf16 v[32:47], v[128:131], v[148:151], v[32:47]
    ds_read_b64 v[142:143], v4 offset:34568
    ds_read_b64_tr_b16 v[168:169], v15 offset:0
    v_exp_f32 v86, v86
    v_exp_f32 v87, v87
    v_exp_f32 v88, v88
    v_exp_f32 v89, v89
    v_mfma_f32_32x32x16_bf16 v[48:63], v[132:135], v[152:155], v[48:63]
    ds_read_b64_tr_b16 v[170:171], v15 offset:288
    ds_read_b64_tr_b16 v[172:173], v15 offset:1152
    v_exp_f32 v90, v90
    v_exp_f32 v91, v91
    v_exp_f32 v92, v92
    v_smfmac_f32_32x32x32_bf16 v[112:127], v[184:187], v[80:87], v16
    ds_read_b64_tr_b16 v[174:175], v15 offset:1440
    v_exp_f32 v93, v93
    v_exp_f32 v94, v94
    v_exp_f32 v95, v95
    s_setprio 1
    v_exp_f32 v32, v32
    v_exp_f32 v33, v33
    v_smfmac_f32_32x32x32_bf16 v[112:127], v[188:191], v[88:95], v16
    ds_read_b32 v144, v7 offset:0
    ds_read_b64_tr_b16 v[176:177], v15 offset:2336
    v_exp_f32 v34, v34
    v_exp_f32 v35, v35
    v_mfma_f32_32x32x4_2b_bf16 v[64:95], v[146:147], v[156:157], 0
    ds_read_b64_tr_b16 v[178:179], v15 offset:2624
    ds_read_b64_tr_b16 v[180:181], v15 offset:3488
    s_waitcnt lgkmcnt(2)
    v_exp_f32 v36, v36
    v_exp_f32 v37, v37
    v_exp_f32 v38, v38
    v_exp_f32 v39, v39
    v_exp_f32 v40, v40
    v_exp_f32 v41, v41
    v_exp_f32 v42, v42
    v_exp_f32 v43, v43
    v_smfmac_f32_32x32x32_bf16 v[96:111], v[160:163], v[32:39], v16
    ds_read_b64_tr_b16 v[182:183], v15 offset:3776
    ds_read_b64 v[128:129], v5 offset:40
    v_exp_f32 v44, v44
    v_exp_f32 v45, v45
    v_exp_f32 v46, v46
    v_exp_f32 v47, v47
    v_exp_f32 v48, v48
    v_exp_f32 v49, v49
    v_smfmac_f32_32x32x32_bf16 v[96:111], v[164:167], v[40:47], v16
    ds_read_b64 v[130:131], v5 offset:48
    ds_read_b64 v[132:133], v5 offset:0
    v_exp_f32 v50, v50
    v_exp_f32 v51, v51
    v_exp_f32 v52, v52
    v_exp_f32 v53, v53
    v_mfma_f32_32x32x16_bf16 v[64:79], v[136:139], v[148:151], v[64:79]
    ds_read_b64 v[134:135], v5 offset:8
    ds_read_b64_tr_b16 v[184:185], v15 offset:2304
    v_exp_f32 v54, v54
    v_exp_f32 v55, v55
    v_exp_f32 v56, v56
    v_exp_f32 v57, v57
    v_mfma_f32_32x32x16_bf16 v[80:95], v[140:143], v[152:155], v[80:95]
    ds_read_b64_tr_b16 v[186:187], v15 offset:2592
    ds_read_b64_tr_b16 v[188:189], v15 offset:3456
    v_exp_f32 v58, v58
    v_exp_f32 v59, v59
    v_exp_f32 v60, v60
    v_smfmac_f32_32x32x32_bf16 v[112:127], v[168:171], v[48:55], v16
    ds_read_b64_tr_b16 v[190:191], v15 offset:3744
    v_exp_f32 v61, v61
    v_exp_f32 v62, v62
    v_exp_f32 v63, v63
    s_setprio 0
    v_exp_f32 v64, v64
    v_exp_f32 v65, v65
    v_smfmac_f32_32x32x32_bf16 v[112:127], v[172:175], v[56:63], v16
    ds_read_b32 v146, v7 offset:2304
    ds_read_b64_tr_b16 v[160:161], v200 offset:32
    v_exp_f32 v66, v66
    v_exp_f32 v67, v67
    v_mfma_f32_32x32x4_2b_bf16 v[32:63], v[144:145], v[156:157], 0
    ds_read_b64_tr_b16 v[162:163], v200 offset:320
    ds_read_b64_tr_b16 v[164:165], v200 offset:1184
    s_waitcnt lgkmcnt(2)
    v_exp_f32 v68, v68
    v_exp_f32 v69, v69
    v_exp_f32 v70, v70
    v_exp_f32 v71, v71
    v_exp_f32 v72, v72
    v_exp_f32 v73, v73
    v_exp_f32 v74, v74
    v_exp_f32 v75, v75
    v_smfmac_f32_32x32x32_bf16 v[96:111], v[176:179], v[64:71], v16
    ds_read_b64_tr_b16 v[166:167], v200 offset:1472
    ds_read_b64 v[136:137], v5 offset:2344
    v_exp_f32 v76, v76
    v_exp_f32 v77, v77
    v_exp_f32 v78, v78
    v_exp_f32 v79, v79
    v_exp_f32 v80, v80
    v_exp_f32 v81, v81
    v_smfmac_f32_32x32x32_bf16 v[96:111], v[180:183], v[72:79], v16
    ds_read_b64 v[138:139], v5 offset:2352
    ds_read_b64 v[140:141], v5 offset:2304
    v_exp_f32 v82, v82
    v_exp_f32 v83, v83
    v_exp_f32 v84, v84
    v_exp_f32 v85, v85
    v_mfma_f32_32x32x16_bf16 v[32:47], v[128:131], v[148:151], v[32:47]
    ds_read_b64 v[142:143], v5 offset:2312
    ds_read_b64_tr_b16 v[168:169], v200 offset:0
    v_exp_f32 v86, v86
    v_exp_f32 v87, v87
    v_exp_f32 v88, v88
    v_exp_f32 v89, v89
    v_mfma_f32_32x32x16_bf16 v[48:63], v[132:135], v[152:155], v[48:63]
    ds_read_b64_tr_b16 v[170:171], v200 offset:288
    ds_read_b64_tr_b16 v[172:173], v200 offset:1152
    v_exp_f32 v90, v90
    v_exp_f32 v91, v91
    v_exp_f32 v92, v92
    v_smfmac_f32_32x32x32_bf16 v[112:127], v[184:187], v[80:87], v16
    ds_read_b64_tr_b16 v[174:175], v200 offset:1440
    v_exp_f32 v93, v93
    v_exp_f32 v94, v94
    v_exp_f32 v95, v95
    s_setprio 3
    v_exp_f32 v32, v32
    v_exp_f32 v33, v33
    v_smfmac_f32_32x32x32_bf16 v[112:127], v[188:191], v[88:95], v16
    ds_read_b32 v144, v7 offset:4608
    ds_read_b64_tr_b16 v[176:177], v200 offset:2336
    v_exp_f32 v34, v34
    v_exp_f32 v35, v35
    v_mfma_f32_32x32x4_2b_bf16 v[64:95], v[146:147], v[156:157], 0
    ds_read_b64_tr_b16 v[178:179], v200 offset:2624
    ds_read_b64_tr_b16 v[180:181], v200 offset:3488
    s_waitcnt lgkmcnt(2)
    v_exp_f32 v36, v36
    v_exp_f32 v37, v37
    v_exp_f32 v38, v38
    v_exp_f32 v39, v39
    v_exp_f32 v40, v40
    v_exp_f32 v41, v41
    v_exp_f32 v42, v42
    v_exp_f32 v43, v43
    v_smfmac_f32_32x32x32_bf16 v[96:111], v[160:163], v[32:39], v16
    ds_read_b64_tr_b16 v[182:183], v200 offset:3776
    ds_read_b64 v[128:129], v5 offset:4648
    v_exp_f32 v44, v44
    v_exp_f32 v45, v45
    v_exp_f32 v46, v46
    v_exp_f32 v47, v47
    v_exp_f32 v48, v48
    v_exp_f32 v49, v49
    v_smfmac_f32_32x32x32_bf16 v[96:111], v[164:167], v[40:47], v16
    ds_read_b64 v[130:131], v5 offset:4656
    ds_read_b64 v[132:133], v5 offset:4608
    v_exp_f32 v50, v50
    v_exp_f32 v51, v51
    v_exp_f32 v52, v52
    v_exp_f32 v53, v53
    v_mfma_f32_32x32x16_bf16 v[64:79], v[136:139], v[148:151], v[64:79]
    ds_read_b64 v[134:135], v5 offset:4616
    ds_read_b64_tr_b16 v[184:185], v200 offset:2304
    v_exp_f32 v54, v54
    v_exp_f32 v55, v55
    v_exp_f32 v56, v56
    v_exp_f32 v57, v57
    v_mfma_f32_32x32x16_bf16 v[80:95], v[140:143], v[152:155], v[80:95]
    ds_read_b64_tr_b16 v[186:187], v200 offset:2592
    ds_read_b64_tr_b16 v[188:189], v200 offset:3456
    v_exp_f32 v58, v58
    v_exp_f32 v59, v59
    v_exp_f32 v60, v60
    v_smfmac_f32_32x32x32_bf16 v[112:127], v[168:171], v[48:55], v16
    ds_read_b64_tr_b16 v[190:191], v200 offset:3744
    v_exp_f32 v61, v61
    v_exp_f32 v62, v62
    v_exp_f32 v63, v63
    s_setprio 2
    v_exp_f32 v64, v64
    v_exp_f32 v65, v65
    v_smfmac_f32_32x32x32_bf16 v[112:127], v[172:175], v[56:63], v16
    ds_read_b32 v146, v7 offset:6912
    ds_read_b64_tr_b16 v[160:161], v201 offset:32
    v_exp_f32 v66, v66
    v_exp_f32 v67, v67
    v_mfma_f32_32x32x4_2b_bf16 v[32:63], v[144:145], v[156:157], 0
    ds_read_b64_tr_b16 v[162:163], v201 offset:320
    ds_read_b64_tr_b16 v[164:165], v201 offset:1184
    s_waitcnt lgkmcnt(2)
    v_exp_f32 v68, v68
    v_exp_f32 v69, v69
    v_exp_f32 v70, v70
    v_exp_f32 v71, v71
    v_exp_f32 v72, v72
    v_exp_f32 v73, v73
    v_exp_f32 v74, v74
    v_exp_f32 v75, v75
    v_smfmac_f32_32x32x32_bf16 v[96:111], v[176:179], v[64:71], v16
    ds_read_b64_tr_b16 v[166:167], v201 offset:1472
    ds_read_b64 v[136:137], v5 offset:6952
    v_exp_f32 v76, v76
    v_exp_f32 v77, v77
    v_exp_f32 v78, v78
    v_exp_f32 v79, v79
    v_exp_f32 v80, v80
    v_exp_f32 v81, v81
    v_smfmac_f32_32x32x32_bf16 v[96:111], v[180:183], v[72:79], v16
    ds_read_b64 v[138:139], v5 offset:6960
    ds_read_b64 v[140:141], v5 offset:6912
    v_exp_f32 v82, v82
    v_exp_f32 v83, v83
    v_exp_f32 v84, v84
    v_exp_f32 v85, v85
    v_mfma_f32_32x32x16_bf16 v[32:47], v[128:131], v[148:151], v[32:47]
    ds_read_b64 v[142:143], v5 offset:6920
    ds_read_b64_tr_b16 v[168:169], v201 offset:0
    v_exp_f32 v86, v86
    v_exp_f32 v87, v87
    v_exp_f32 v88, v88
    v_exp_f32 v89, v89
    v_mfma_f32_32x32x16_bf16 v[48:63], v[132:135], v[152:155], v[48:63]
    ds_read_b64_tr_b16 v[170:171], v201 offset:288
    ds_read_b64_tr_b16 v[172:173], v201 offset:1152
    v_exp_f32 v90, v90
    v_exp_f32 v91, v91
    v_exp_f32 v92, v92
    v_smfmac_f32_32x32x32_bf16 v[112:127], v[184:187], v[80:87], v16
    ds_read_b64_tr_b16 v[174:175], v201 offset:1440
    v_exp_f32 v93, v93
    v_exp_f32 v94, v94
    v_exp_f32 v95, v95
    s_setprio 1
    v_exp_f32 v32, v32
    v_exp_f32 v33, v33
    v_smfmac_f32_32x32x32_bf16 v[112:127], v[188:191], v[88:95], v16
    ds_read_b32 v144, v7 offset:9216
    ds_read_b64_tr_b16 v[176:177], v201 offset:2336
    v_exp_f32 v34, v34
    v_exp_f32 v35, v35
    v_mfma_f32_32x32x4_2b_bf16 v[64:95], v[146:147], v[156:157], 0
    ds_read_b64_tr_b16 v[178:179], v201 offset:2624
    ds_read_b64_tr_b16 v[180:181], v201 offset:3488
    s_waitcnt lgkmcnt(2)
    v_exp_f32 v36, v36
    v_exp_f32 v37, v37
    v_exp_f32 v38, v38
    v_exp_f32 v39, v39
    v_exp_f32 v40, v40
    v_exp_f32 v41, v41
    v_exp_f32 v42, v42
    v_exp_f32 v43, v43
    v_smfmac_f32_32x32x32_bf16 v[96:111], v[160:163], v[32:39], v16
    ds_read_b64_tr_b16 v[182:183], v201 offset:3776
    ds_read_b64 v[128:129], v5 offset:9256
    v_exp_f32 v44, v44
    v_exp_f32 v45, v45
    v_exp_f32 v46, v46
    v_exp_f32 v47, v47
    v_exp_f32 v48, v48
    v_exp_f32 v49, v49
    v_smfmac_f32_32x32x32_bf16 v[96:111], v[164:167], v[40:47], v16
    ds_read_b64 v[130:131], v5 offset:9264
    ds_read_b64 v[132:133], v5 offset:9216
    v_exp_f32 v50, v50
    v_exp_f32 v51, v51
    v_exp_f32 v52, v52
    v_exp_f32 v53, v53
    v_mfma_f32_32x32x16_bf16 v[64:79], v[136:139], v[148:151], v[64:79]
    ds_read_b64 v[134:135], v5 offset:9224
    ds_read_b64_tr_b16 v[184:185], v201 offset:2304
    v_exp_f32 v54, v54
    v_exp_f32 v55, v55
    v_exp_f32 v56, v56
    v_exp_f32 v57, v57
    v_mfma_f32_32x32x16_bf16 v[80:95], v[140:143], v[152:155], v[80:95]
    ds_read_b64_tr_b16 v[186:187], v201 offset:2592
    ds_read_b64_tr_b16 v[188:189], v201 offset:3456
    v_exp_f32 v58, v58
    v_exp_f32 v59, v59
    v_exp_f32 v60, v60
    v_smfmac_f32_32x32x32_bf16 v[112:127], v[168:171], v[48:55], v16
    ds_read_b64_tr_b16 v[190:191], v201 offset:3744
    v_exp_f32 v61, v61
    v_exp_f32 v62, v62
    v_exp_f32 v63, v63
    s_setprio 0
    v_exp_f32 v64, v64
    v_exp_f32 v65, v65
    v_smfmac_f32_32x32x32_bf16 v[112:127], v[172:175], v[56:63], v16
    ds_read_b32 v146, v7 offset:11520
    ds_read_b64_tr_b16 v[160:161], v202 offset:32
    v_exp_f32 v66, v66
    v_exp_f32 v67, v67
    v_mfma_f32_32x32x4_2b_bf16 v[32:63], v[144:145], v[156:157], 0
    ds_read_b64_tr_b16 v[162:163], v202 offset:320
    ds_read_b64_tr_b16 v[164:165], v202 offset:1184
    s_waitcnt lgkmcnt(2)
    v_exp_f32 v68, v68
    v_exp_f32 v69, v69
    v_exp_f32 v70, v70
    v_exp_f32 v71, v71
    v_exp_f32 v72, v72
    v_exp_f32 v73, v73
    v_exp_f32 v74, v74
    v_exp_f32 v75, v75
    v_smfmac_f32_32x32x32_bf16 v[96:111], v[176:179], v[64:71], v16
    ds_read_b64_tr_b16 v[166:167], v202 offset:1472
    ds_read_b64 v[136:137], v5 offset:11560
    v_exp_f32 v76, v76
    v_exp_f32 v77, v77
    v_exp_f32 v78, v78
    v_exp_f32 v79, v79
    v_exp_f32 v80, v80
    v_exp_f32 v81, v81
    v_smfmac_f32_32x32x32_bf16 v[96:111], v[180:183], v[72:79], v16
    ds_read_b64 v[138:139], v5 offset:11568
    ds_read_b64 v[140:141], v5 offset:11520
    v_exp_f32 v82, v82
    v_exp_f32 v83, v83
    v_exp_f32 v84, v84
    v_exp_f32 v85, v85
    v_mfma_f32_32x32x16_bf16 v[32:47], v[128:131], v[148:151], v[32:47]
    ds_read_b64 v[142:143], v5 offset:11528
    ds_read_b64_tr_b16 v[168:169], v202 offset:0
    v_exp_f32 v86, v86
    v_exp_f32 v87, v87
    v_exp_f32 v88, v88
    v_exp_f32 v89, v89
    v_mfma_f32_32x32x16_bf16 v[48:63], v[132:135], v[152:155], v[48:63]
    ds_read_b64_tr_b16 v[170:171], v202 offset:288
    ds_read_b64_tr_b16 v[172:173], v202 offset:1152
    v_exp_f32 v90, v90
    v_exp_f32 v91, v91
    v_exp_f32 v92, v92
    v_smfmac_f32_32x32x32_bf16 v[112:127], v[184:187], v[80:87], v16
    ds_read_b64_tr_b16 v[174:175], v202 offset:1440
    v_exp_f32 v93, v93
    v_exp_f32 v94, v94
    v_exp_f32 v95, v95
    s_setprio 3
    v_exp_f32 v32, v32
    v_exp_f32 v33, v33
    v_smfmac_f32_32x32x32_bf16 v[112:127], v[188:191], v[88:95], v16
    ds_read_b32 v144, v7 offset:13824
    ds_read_b64_tr_b16 v[176:177], v202 offset:2336
    v_exp_f32 v34, v34
    v_exp_f32 v35, v35
    v_mfma_f32_32x32x4_2b_bf16 v[64:95], v[146:147], v[156:157], 0
    ds_read_b64_tr_b16 v[178:179], v202 offset:2624
    ds_read_b64_tr_b16 v[180:181], v202 offset:3488
    s_waitcnt lgkmcnt(2)
    v_exp_f32 v36, v36
    v_exp_f32 v37, v37
    v_exp_f32 v38, v38
    v_exp_f32 v39, v39
    v_exp_f32 v40, v40
    v_exp_f32 v41, v41
    v_exp_f32 v42, v42
    v_exp_f32 v43, v43
    v_smfmac_f32_32x32x32_bf16 v[96:111], v[160:163], v[32:39], v16
    ds_read_b64_tr_b16 v[182:183], v202 offset:3776
    ds_read_b64 v[128:129], v5 offset:13864
    v_exp_f32 v44, v44
    v_exp_f32 v45, v45
    v_exp_f32 v46, v46
    v_exp_f32 v47, v47
    v_exp_f32 v48, v48
    v_exp_f32 v49, v49
    v_smfmac_f32_32x32x32_bf16 v[96:111], v[164:167], v[40:47], v16
    ds_read_b64 v[130:131], v5 offset:13872
    ds_read_b64 v[132:133], v5 offset:13824
    v_exp_f32 v50, v50
    v_exp_f32 v51, v51
    v_exp_f32 v52, v52
    v_exp_f32 v53, v53
    v_mfma_f32_32x32x16_bf16 v[64:79], v[136:139], v[148:151], v[64:79]
    ds_read_b64 v[134:135], v5 offset:13832
    ds_read_b64_tr_b16 v[184:185], v202 offset:2304
    v_exp_f32 v54, v54
    v_exp_f32 v55, v55
    v_exp_f32 v56, v56
    v_exp_f32 v57, v57
    v_mfma_f32_32x32x16_bf16 v[80:95], v[140:143], v[152:155], v[80:95]
    ds_read_b64_tr_b16 v[186:187], v202 offset:2592
    ds_read_b64_tr_b16 v[188:189], v202 offset:3456
    v_exp_f32 v58, v58
    v_exp_f32 v59, v59
    v_exp_f32 v60, v60
    v_smfmac_f32_32x32x32_bf16 v[112:127], v[168:171], v[48:55], v16
    ds_read_b64_tr_b16 v[190:191], v202 offset:3744
    v_exp_f32 v61, v61
    v_exp_f32 v62, v62
    v_exp_f32 v63, v63
    s_setprio 2
    v_exp_f32 v64, v64
    v_exp_f32 v65, v65
    v_smfmac_f32_32x32x32_bf16 v[112:127], v[172:175], v[56:63], v16
    ds_read_b32 v146, v7 offset:16128
    ds_read_b64_tr_b16 v[160:161], v203 offset:32
    v_exp_f32 v66, v66
    v_exp_f32 v67, v67
    v_mfma_f32_32x32x4_2b_bf16 v[32:63], v[144:145], v[156:157], 0
    ds_read_b64_tr_b16 v[162:163], v203 offset:320
    ds_read_b64_tr_b16 v[164:165], v203 offset:1184
    s_waitcnt lgkmcnt(2)
    v_exp_f32 v68, v68
    v_exp_f32 v69, v69
    v_exp_f32 v70, v70
    v_exp_f32 v71, v71
    v_exp_f32 v72, v72
    v_exp_f32 v73, v73
    v_exp_f32 v74, v74
    v_exp_f32 v75, v75
    v_smfmac_f32_32x32x32_bf16 v[96:111], v[176:179], v[64:71], v16
    ds_read_b64_tr_b16 v[166:167], v203 offset:1472
    ds_read_b64 v[136:137], v5 offset:16168
    v_exp_f32 v76, v76
    v_exp_f32 v77, v77
    v_exp_f32 v78, v78
    v_exp_f32 v79, v79
    v_exp_f32 v80, v80
    v_exp_f32 v81, v81
    v_smfmac_f32_32x32x32_bf16 v[96:111], v[180:183], v[72:79], v16
    ds_read_b64 v[138:139], v5 offset:16176
    ds_read_b64 v[140:141], v5 offset:16128
    v_exp_f32 v82, v82
    v_exp_f32 v83, v83
    v_exp_f32 v84, v84
    v_exp_f32 v85, v85
    v_mfma_f32_32x32x16_bf16 v[32:47], v[128:131], v[148:151], v[32:47]
    ds_read_b64 v[142:143], v5 offset:16136
    ds_read_b64_tr_b16 v[168:169], v203 offset:0
    v_exp_f32 v86, v86
    v_exp_f32 v87, v87
    v_exp_f32 v88, v88
    v_exp_f32 v89, v89
    v_mfma_f32_32x32x16_bf16 v[48:63], v[132:135], v[152:155], v[48:63]
    ds_read_b64_tr_b16 v[170:171], v203 offset:288
    ds_read_b64_tr_b16 v[172:173], v203 offset:1152
    v_exp_f32 v90, v90
    v_exp_f32 v91, v91
    v_exp_f32 v92, v92
    v_smfmac_f32_32x32x32_bf16 v[112:127], v[184:187], v[80:87], v16
    ds_read_b64_tr_b16 v[174:175], v203 offset:1440
    v_exp_f32 v93, v93
    v_exp_f32 v94, v94
    v_exp_f32 v95, v95
    s_setprio 1
    v_exp_f32 v32, v32
    v_exp_f32 v33, v33
    v_smfmac_f32_32x32x32_bf16 v[112:127], v[188:191], v[88:95], v16
    ds_read_b32 v144, v7 offset:18432
    ds_read_b64_tr_b16 v[176:177], v203 offset:2336
    v_exp_f32 v34, v34
    v_exp_f32 v35, v35
    v_mfma_f32_32x32x4_2b_bf16 v[64:95], v[146:147], v[156:157], 0
    ds_read_b64_tr_b16 v[178:179], v203 offset:2624
    ds_read_b64_tr_b16 v[180:181], v203 offset:3488
    s_waitcnt lgkmcnt(2)
    v_exp_f32 v36, v36
    v_exp_f32 v37, v37
    v_exp_f32 v38, v38
    v_exp_f32 v39, v39
    v_exp_f32 v40, v40
    v_exp_f32 v41, v41
    v_exp_f32 v42, v42
    v_exp_f32 v43, v43
    v_smfmac_f32_32x32x32_bf16 v[96:111], v[160:163], v[32:39], v16
    ds_read_b64_tr_b16 v[182:183], v203 offset:3776
    ds_read_b64 v[128:129], v5 offset:18472
    v_exp_f32 v44, v44
    v_exp_f32 v45, v45
    v_exp_f32 v46, v46
    v_exp_f32 v47, v47
    v_exp_f32 v48, v48
    v_exp_f32 v49, v49
    v_smfmac_f32_32x32x32_bf16 v[96:111], v[164:167], v[40:47], v16
    ds_read_b64 v[130:131], v5 offset:18480
    ds_read_b64 v[132:133], v5 offset:18432
    v_exp_f32 v50, v50
    v_exp_f32 v51, v51
    v_exp_f32 v52, v52
    v_exp_f32 v53, v53
    v_mfma_f32_32x32x16_bf16 v[64:79], v[136:139], v[148:151], v[64:79]
    ds_read_b64 v[134:135], v5 offset:18440
    ds_read_b64_tr_b16 v[184:185], v203 offset:2304
    v_exp_f32 v54, v54
    v_exp_f32 v55, v55
    v_exp_f32 v56, v56
    v_exp_f32 v57, v57
    v_mfma_f32_32x32x16_bf16 v[80:95], v[140:143], v[152:155], v[80:95]
    ds_read_b64_tr_b16 v[186:187], v203 offset:2592
    ds_read_b64_tr_b16 v[188:189], v203 offset:3456
    v_exp_f32 v58, v58
    v_exp_f32 v59, v59
    v_exp_f32 v60, v60
    v_smfmac_f32_32x32x32_bf16 v[112:127], v[168:171], v[48:55], v16
    ds_read_b64_tr_b16 v[190:191], v203 offset:3744
    v_exp_f32 v61, v61
    v_exp_f32 v62, v62
    v_exp_f32 v63, v63
    s_setprio 0
    v_exp_f32 v64, v64
    v_exp_f32 v65, v65
    v_smfmac_f32_32x32x32_bf16 v[112:127], v[172:175], v[56:63], v16
    ds_read_b32 v146, v7 offset:20736
    ds_read_b64_tr_b16 v[160:161], v204 offset:32
    v_exp_f32 v66, v66
    v_exp_f32 v67, v67
    v_mfma_f32_32x32x4_2b_bf16 v[32:63], v[144:145], v[156:157], 0
    ds_read_b64_tr_b16 v[162:163], v204 offset:320
    ds_read_b64_tr_b16 v[164:165], v204 offset:1184
    s_waitcnt lgkmcnt(2)
    v_exp_f32 v68, v68
    v_exp_f32 v69, v69
    v_exp_f32 v70, v70
    v_exp_f32 v71, v71
    v_exp_f32 v72, v72
    v_exp_f32 v73, v73
    v_exp_f32 v74, v74
    v_exp_f32 v75, v75
    v_smfmac_f32_32x32x32_bf16 v[96:111], v[176:179], v[64:71], v16
    ds_read_b64_tr_b16 v[166:167], v204 offset:1472
    ds_read_b64 v[136:137], v5 offset:20776
    v_exp_f32 v76, v76
    v_exp_f32 v77, v77
    v_exp_f32 v78, v78
    v_exp_f32 v79, v79
    v_exp_f32 v80, v80
    v_exp_f32 v81, v81
    v_smfmac_f32_32x32x32_bf16 v[96:111], v[180:183], v[72:79], v16
    ds_read_b64 v[138:139], v5 offset:20784
    ds_read_b64 v[140:141], v5 offset:20736
    v_exp_f32 v82, v82
    v_exp_f32 v83, v83
    v_exp_f32 v84, v84
    v_exp_f32 v85, v85
    v_mfma_f32_32x32x16_bf16 v[32:47], v[128:131], v[148:151], v[32:47]
    ds_read_b64 v[142:143], v5 offset:20744
    ds_read_b64_tr_b16 v[168:169], v204 offset:0
    v_exp_f32 v86, v86
    v_exp_f32 v87, v87
    v_exp_f32 v88, v88
    v_exp_f32 v89, v89
    v_mfma_f32_32x32x16_bf16 v[48:63], v[132:135], v[152:155], v[48:63]
    ds_read_b64_tr_b16 v[170:171], v204 offset:288
    ds_read_b64_tr_b16 v[172:173], v204 offset:1152
    v_exp_f32 v90, v90
    v_exp_f32 v91, v91
    v_exp_f32 v92, v92
    v_smfmac_f32_32x32x32_bf16 v[112:127], v[184:187], v[80:87], v16
    ds_read_b64_tr_b16 v[174:175], v204 offset:1440
    v_exp_f32 v93, v93
    v_exp_f32 v94, v94
    v_exp_f32 v95, v95
    s_setprio 3
    v_exp_f32 v32, v32
    v_exp_f32 v33, v33
    v_smfmac_f32_32x32x32_bf16 v[112:127], v[188:191], v[88:95], v16
    ds_read_b32 v144, v7 offset:23040
    ds_read_b64_tr_b16 v[176:177], v204 offset:2336
    v_exp_f32 v34, v34
    v_exp_f32 v35, v35
    v_mfma_f32_32x32x4_2b_bf16 v[64:95], v[146:147], v[156:157], 0
    ds_read_b64_tr_b16 v[178:179], v204 offset:2624
    ds_read_b64_tr_b16 v[180:181], v204 offset:3488
    s_waitcnt lgkmcnt(2)
    v_exp_f32 v36, v36
    v_exp_f32 v37, v37
    v_exp_f32 v38, v38
    v_exp_f32 v39, v39
    v_exp_f32 v40, v40
    v_exp_f32 v41, v41
    v_exp_f32 v42, v42
    v_exp_f32 v43, v43
    v_smfmac_f32_32x32x32_bf16 v[96:111], v[160:163], v[32:39], v16
    ds_read_b64_tr_b16 v[182:183], v204 offset:3776
    ds_read_b64 v[128:129], v5 offset:23080
    v_exp_f32 v44, v44
    v_exp_f32 v45, v45
    v_exp_f32 v46, v46
    v_exp_f32 v47, v47
    v_exp_f32 v48, v48
    v_exp_f32 v49, v49
    v_smfmac_f32_32x32x32_bf16 v[96:111], v[164:167], v[40:47], v16
    ds_read_b64 v[130:131], v5 offset:23088
    ds_read_b64 v[132:133], v5 offset:23040
    v_exp_f32 v50, v50
    v_exp_f32 v51, v51
    v_exp_f32 v52, v52
    v_exp_f32 v53, v53
    v_mfma_f32_32x32x16_bf16 v[64:79], v[136:139], v[148:151], v[64:79]
    ds_read_b64 v[134:135], v5 offset:23048
    ds_read_b64_tr_b16 v[184:185], v204 offset:2304
    v_exp_f32 v54, v54
    v_exp_f32 v55, v55
    v_exp_f32 v56, v56
    v_exp_f32 v57, v57
    v_mfma_f32_32x32x16_bf16 v[80:95], v[140:143], v[152:155], v[80:95]
    ds_read_b64_tr_b16 v[186:187], v204 offset:2592
    ds_read_b64_tr_b16 v[188:189], v204 offset:3456
    v_exp_f32 v58, v58
    v_exp_f32 v59, v59
    v_exp_f32 v60, v60
    v_smfmac_f32_32x32x32_bf16 v[112:127], v[168:171], v[48:55], v16
    ds_read_b64_tr_b16 v[190:191], v204 offset:3744
    v_exp_f32 v61, v61
    v_exp_f32 v62, v62
    v_exp_f32 v63, v63
    s_setprio 2
    v_exp_f32 v64, v64
    v_exp_f32 v65, v65
    v_smfmac_f32_32x32x32_bf16 v[112:127], v[172:175], v[56:63], v16
    ds_read_b32 v146, v7 offset:25344
    ds_read_b64_tr_b16 v[160:161], v205 offset:32
    v_exp_f32 v66, v66
    v_exp_f32 v67, v67
    v_mfma_f32_32x32x4_2b_bf16 v[32:63], v[144:145], v[156:157], 0
    ds_read_b64_tr_b16 v[162:163], v205 offset:320
    ds_read_b64_tr_b16 v[164:165], v205 offset:1184
    s_waitcnt lgkmcnt(2)
    v_exp_f32 v68, v68
    v_exp_f32 v69, v69
    v_exp_f32 v70, v70
    v_exp_f32 v71, v71
    v_exp_f32 v72, v72
    v_exp_f32 v73, v73
    v_exp_f32 v74, v74
    v_exp_f32 v75, v75
    v_smfmac_f32_32x32x32_bf16 v[96:111], v[176:179], v[64:71], v16
    ds_read_b64_tr_b16 v[166:167], v205 offset:1472
    ds_read_b64 v[136:137], v5 offset:25384
    v_exp_f32 v76, v76
    v_exp_f32 v77, v77
    v_exp_f32 v78, v78
    v_exp_f32 v79, v79
    v_exp_f32 v80, v80
    v_exp_f32 v81, v81
    v_smfmac_f32_32x32x32_bf16 v[96:111], v[180:183], v[72:79], v16
    ds_read_b64 v[138:139], v5 offset:25392
    ds_read_b64 v[140:141], v5 offset:25344
    v_exp_f32 v82, v82
    v_exp_f32 v83, v83
    v_exp_f32 v84, v84
    v_exp_f32 v85, v85
    v_mfma_f32_32x32x16_bf16 v[32:47], v[128:131], v[148:151], v[32:47]
    ds_read_b64 v[142:143], v5 offset:25352
    ds_read_b64_tr_b16 v[168:169], v205 offset:0
    v_exp_f32 v86, v86
    v_exp_f32 v87, v87
    v_exp_f32 v88, v88
    v_exp_f32 v89, v89
    v_mfma_f32_32x32x16_bf16 v[48:63], v[132:135], v[152:155], v[48:63]
    ds_read_b64_tr_b16 v[170:171], v205 offset:288
    ds_read_b64_tr_b16 v[172:173], v205 offset:1152
    v_exp_f32 v90, v90
    v_exp_f32 v91, v91
    v_exp_f32 v92, v92
    v_smfmac_f32_32x32x32_bf16 v[112:127], v[184:187], v[80:87], v16
    ds_read_b64_tr_b16 v[174:175], v205 offset:1440
    v_exp_f32 v93, v93
    v_exp_f32 v94, v94
    v_exp_f32 v95, v95
    s_setprio 1
    v_exp_f32 v32, v32
    v_exp_f32 v33, v33
    v_smfmac_f32_32x32x32_bf16 v[112:127], v[188:191], v[88:95], v16
    ds_read_b32 v144, v7 offset:27648
    ds_read_b64_tr_b16 v[176:177], v205 offset:2336
    v_exp_f32 v34, v34
    v_exp_f32 v35, v35
    v_mfma_f32_32x32x4_2b_bf16 v[64:95], v[146:147], v[156:157], 0
    ds_read_b64_tr_b16 v[178:179], v205 offset:2624
    ds_read_b64_tr_b16 v[180:181], v205 offset:3488
    s_waitcnt lgkmcnt(2)
    v_exp_f32 v36, v36
    v_exp_f32 v37, v37
    v_exp_f32 v38, v38
    v_exp_f32 v39, v39
    v_exp_f32 v40, v40
    v_exp_f32 v41, v41
    v_exp_f32 v42, v42
    v_exp_f32 v43, v43
    v_smfmac_f32_32x32x32_bf16 v[96:111], v[160:163], v[32:39], v16
    ds_read_b64_tr_b16 v[182:183], v205 offset:3776
    ds_read_b64 v[128:129], v5 offset:27688
    v_exp_f32 v44, v44
    v_exp_f32 v45, v45
    v_exp_f32 v46, v46
    v_exp_f32 v47, v47
    v_exp_f32 v48, v48
    v_exp_f32 v49, v49
    v_smfmac_f32_32x32x32_bf16 v[96:111], v[164:167], v[40:47], v16
    ds_read_b64 v[130:131], v5 offset:27696
    ds_read_b64 v[132:133], v5 offset:27648
    v_exp_f32 v50, v50
    v_exp_f32 v51, v51
    v_exp_f32 v52, v52
    v_exp_f32 v53, v53
    v_mfma_f32_32x32x16_bf16 v[64:79], v[136:139], v[148:151], v[64:79]
    ds_read_b64 v[134:135], v5 offset:27656
    ds_read_b64_tr_b16 v[184:185], v205 offset:2304
    v_exp_f32 v54, v54
    v_exp_f32 v55, v55
    v_exp_f32 v56, v56
    v_exp_f32 v57, v57
    v_mfma_f32_32x32x16_bf16 v[80:95], v[140:143], v[152:155], v[80:95]
    ds_read_b64_tr_b16 v[186:187], v205 offset:2592
    ds_read_b64_tr_b16 v[188:189], v205 offset:3456
    v_exp_f32 v58, v58
    v_exp_f32 v59, v59
    v_exp_f32 v60, v60
    v_smfmac_f32_32x32x32_bf16 v[112:127], v[168:171], v[48:55], v16
    ds_read_b64_tr_b16 v[190:191], v205 offset:3744
    v_exp_f32 v61, v61
    v_exp_f32 v62, v62
    v_exp_f32 v63, v63
    s_setprio 0
    v_exp_f32 v64, v64
    v_exp_f32 v65, v65
    v_smfmac_f32_32x32x32_bf16 v[112:127], v[172:175], v[56:63], v16
    ds_read_b32 v146, v7 offset:29952
    ds_read_b64_tr_b16 v[160:161], v206 offset:32
    v_exp_f32 v66, v66
    v_exp_f32 v67, v67
    v_mfma_f32_32x32x4_2b_bf16 v[32:63], v[144:145], v[156:157], 0
    ds_read_b64_tr_b16 v[162:163], v206 offset:320
    ds_read_b64_tr_b16 v[164:165], v206 offset:1184
    s_waitcnt lgkmcnt(2)
    v_exp_f32 v68, v68
    v_exp_f32 v69, v69
    v_exp_f32 v70, v70
    v_exp_f32 v71, v71
    v_exp_f32 v72, v72
    v_exp_f32 v73, v73
    v_exp_f32 v74, v74
    v_exp_f32 v75, v75
    v_smfmac_f32_32x32x32_bf16 v[96:111], v[176:179], v[64:71], v16
    ds_read_b64_tr_b16 v[166:167], v206 offset:1472
    ds_read_b64 v[136:137], v5 offset:29992
    v_exp_f32 v76, v76
    v_exp_f32 v77, v77
    v_exp_f32 v78, v78
    v_exp_f32 v79, v79
    v_exp_f32 v80, v80
    v_exp_f32 v81, v81
    v_smfmac_f32_32x32x32_bf16 v[96:111], v[180:183], v[72:79], v16
    ds_read_b64 v[138:139], v5 offset:30000
    ds_read_b64 v[140:141], v5 offset:29952
    v_exp_f32 v82, v82
    v_exp_f32 v83, v83
    v_exp_f32 v84, v84
    v_exp_f32 v85, v85
    v_mfma_f32_32x32x16_bf16 v[32:47], v[128:131], v[148:151], v[32:47]
    ds_read_b64 v[142:143], v5 offset:29960
    ds_read_b64_tr_b16 v[168:169], v206 offset:0
    v_exp_f32 v86, v86
    v_exp_f32 v87, v87
    v_exp_f32 v88, v88
    v_exp_f32 v89, v89
    v_mfma_f32_32x32x16_bf16 v[48:63], v[132:135], v[152:155], v[48:63]
    ds_read_b64_tr_b16 v[170:171], v206 offset:288
    ds_read_b64_tr_b16 v[172:173], v206 offset:1152
    v_exp_f32 v90, v90
    v_exp_f32 v91, v91
    v_exp_f32 v92, v92
    v_smfmac_f32_32x32x32_bf16 v[112:127], v[184:187], v[80:87], v16
    ds_read_b64_tr_b16 v[174:175], v206 offset:1440
    v_exp_f32 v93, v93
    v_exp_f32 v94, v94
    v_exp_f32 v95, v95
    s_setprio 3
    v_exp_f32 v32, v32
    v_exp_f32 v33, v33
    v_smfmac_f32_32x32x32_bf16 v[112:127], v[188:191], v[88:95], v16
    ds_read_b32 v144, v7 offset:32256
    ds_read_b64_tr_b16 v[176:177], v206 offset:2336
    v_exp_f32 v34, v34
    v_exp_f32 v35, v35
    v_mfma_f32_32x32x4_2b_bf16 v[64:95], v[146:147], v[156:157], 0
    ds_read_b64_tr_b16 v[178:179], v206 offset:2624
    ds_read_b64_tr_b16 v[180:181], v206 offset:3488
    s_waitcnt lgkmcnt(2)
    v_exp_f32 v36, v36
    v_exp_f32 v37, v37
    v_exp_f32 v38, v38
    v_exp_f32 v39, v39
    v_exp_f32 v40, v40
    v_exp_f32 v41, v41
    v_exp_f32 v42, v42
    v_exp_f32 v43, v43
    v_smfmac_f32_32x32x32_bf16 v[96:111], v[160:163], v[32:39], v16
    ds_read_b64_tr_b16 v[182:183], v206 offset:3776
    ds_read_b64 v[128:129], v5 offset:32296
    v_exp_f32 v44, v44
    v_exp_f32 v45, v45
    v_exp_f32 v46, v46
    v_exp_f32 v47, v47
    v_exp_f32 v48, v48
    v_exp_f32 v49, v49
    v_smfmac_f32_32x32x32_bf16 v[96:111], v[164:167], v[40:47], v16
    ds_read_b64 v[130:131], v5 offset:32304
    ds_read_b64 v[132:133], v5 offset:32256
    v_exp_f32 v50, v50
    v_exp_f32 v51, v51
    v_exp_f32 v52, v52
    v_exp_f32 v53, v53
    v_mfma_f32_32x32x16_bf16 v[64:79], v[136:139], v[148:151], v[64:79]
    ds_read_b64 v[134:135], v5 offset:32264
    ds_read_b64_tr_b16 v[184:185], v206 offset:2304
    v_exp_f32 v54, v54
    v_exp_f32 v55, v55
    v_exp_f32 v56, v56
    v_exp_f32 v57, v57
    v_mfma_f32_32x32x16_bf16 v[80:95], v[140:143], v[152:155], v[80:95]
    ds_read_b64_tr_b16 v[186:187], v206 offset:2592
    ds_read_b64_tr_b16 v[188:189], v206 offset:3456
    v_exp_f32 v58, v58
    v_exp_f32 v59, v59
    v_exp_f32 v60, v60
    v_smfmac_f32_32x32x32_bf16 v[112:127], v[168:171], v[48:55], v16
    ds_read_b64_tr_b16 v[190:191], v206 offset:3744
    v_exp_f32 v61, v61
    v_exp_f32 v62, v62
    v_exp_f32 v63, v63
    s_setprio 2
    v_exp_f32 v64, v64
    v_exp_f32 v65, v65
    v_smfmac_f32_32x32x32_bf16 v[112:127], v[172:175], v[56:63], v16
    ds_read_b32 v146, v7 offset:34560
    ds_read_b64_tr_b16 v[160:161], v207 offset:32
    v_exp_f32 v66, v66
    v_exp_f32 v67, v67
    v_mfma_f32_32x32x4_2b_bf16 v[32:63], v[144:145], v[156:157], 0
    ds_read_b64_tr_b16 v[162:163], v207 offset:320
    ds_read_b64_tr_b16 v[164:165], v207 offset:1184
    s_waitcnt lgkmcnt(2)
    v_exp_f32 v68, v68
    v_exp_f32 v69, v69
    v_exp_f32 v70, v70
    v_exp_f32 v71, v71
    v_exp_f32 v72, v72
    v_exp_f32 v73, v73
    v_exp_f32 v74, v74
    v_exp_f32 v75, v75
    v_smfmac_f32_32x32x32_bf16 v[96:111], v[176:179], v[64:71], v16
    ds_read_b64_tr_b16 v[166:167], v207 offset:1472
    ds_read_b64 v[136:137], v5 offset:34600
    v_exp_f32 v76, v76
    v_exp_f32 v77, v77
    v_exp_f32 v78, v78
    v_exp_f32 v79, v79
    v_exp_f32 v80, v80
    v_exp_f32 v81, v81
    v_smfmac_f32_32x32x32_bf16 v[96:111], v[180:183], v[72:79], v16
    ds_read_b64 v[138:139], v5 offset:34608
    ds_read_b64 v[140:141], v5 offset:34560
    v_exp_f32 v82, v82
    v_exp_f32 v83, v83
    v_exp_f32 v84, v84
    v_exp_f32 v85, v85
    v_mfma_f32_32x32x16_bf16 v[32:47], v[128:131], v[148:151], v[32:47]
    ds_read_b64 v[142:143], v5 offset:34568
    ds_read_b64_tr_b16 v[168:169], v207 offset:0
    v_exp_f32 v86, v86
    v_exp_f32 v87, v87
    v_exp_f32 v88, v88
    v_exp_f32 v89, v89
    v_mfma_f32_32x32x16_bf16 v[48:63], v[132:135], v[152:155], v[48:63]
    ds_read_b64_tr_b16 v[170:171], v207 offset:288
    ds_read_b64_tr_b16 v[172:173], v207 offset:1152
    v_exp_f32 v90, v90
    v_exp_f32 v91, v91
    v_exp_f32 v92, v92
    v_smfmac_f32_32x32x32_bf16 v[112:127], v[184:187], v[80:87], v16
    ds_read_b64_tr_b16 v[174:175], v207 offset:1440
    v_exp_f32 v93, v93
    v_exp_f32 v94, v94
    v_exp_f32 v95, v95
    s_setprio 1
    v_exp_f32 v32, v32
    v_exp_f32 v33, v33
    v_smfmac_f32_32x32x32_bf16 v[112:127], v[188:191], v[88:95], v16
    ds_read_b64_tr_b16 v[176:177], v207 offset:2336
    v_exp_f32 v34, v34
    v_exp_f32 v35, v35
    v_mfma_f32_32x32x4_2b_bf16 v[64:95], v[146:147], v[156:157], 0
    ds_read_b64_tr_b16 v[178:179], v207 offset:2624
    ds_read_b64_tr_b16 v[180:181], v207 offset:3488
    s_waitcnt lgkmcnt(2)
    v_exp_f32 v36, v36
    v_exp_f32 v37, v37
    v_exp_f32 v38, v38
    v_exp_f32 v39, v39
    v_exp_f32 v40, v40
    v_exp_f32 v41, v41
    v_exp_f32 v42, v42
    v_exp_f32 v43, v43
    v_smfmac_f32_32x32x32_bf16 v[96:111], v[160:163], v[32:39], v16
    ds_read_b64_tr_b16 v[182:183], v207 offset:3776
    v_exp_f32 v44, v44
    v_exp_f32 v45, v45
    v_exp_f32 v46, v46
    v_exp_f32 v47, v47
    v_exp_f32 v48, v48
    v_exp_f32 v49, v49
    v_smfmac_f32_32x32x32_bf16 v[96:111], v[164:167], v[40:47], v16
    v_exp_f32 v50, v50
    v_exp_f32 v51, v51
    v_exp_f32 v52, v52
    v_exp_f32 v53, v53
    v_mfma_f32_32x32x16_bf16 v[64:79], v[136:139], v[148:151], v[64:79]
    ds_read_b64_tr_b16 v[184:185], v207 offset:2304
    v_exp_f32 v54, v54
    v_exp_f32 v55, v55
    v_exp_f32 v56, v56
    v_exp_f32 v57, v57
    v_mfma_f32_32x32x16_bf16 v[80:95], v[140:143], v[152:155], v[80:95]
    ds_read_b64_tr_b16 v[186:187], v207 offset:2592
    ds_read_b64_tr_b16 v[188:189], v207 offset:3456
    v_exp_f32 v58, v58
    v_exp_f32 v59, v59
    v_exp_f32 v60, v60
    v_smfmac_f32_32x32x32_bf16 v[112:127], v[168:171], v[48:55], v16
    ds_read_b64_tr_b16 v[190:191], v207 offset:3744
    v_exp_f32 v61, v61
    v_exp_f32 v62, v62
    v_exp_f32 v63, v63
    s_setprio 0
    v_exp_f32 v64, v64
    v_exp_f32 v65, v65
    v_smfmac_f32_32x32x32_bf16 v[112:127], v[172:175], v[56:63], v16
    v_exp_f32 v66, v66
    v_exp_f32 v67, v67
    s_waitcnt lgkmcnt(2)
    v_exp_f32 v68, v68
    v_exp_f32 v69, v69
    v_exp_f32 v70, v70
    v_exp_f32 v71, v71
    v_exp_f32 v72, v72
    v_exp_f32 v73, v73
    v_exp_f32 v74, v74
    v_exp_f32 v75, v75
    v_smfmac_f32_32x32x32_bf16 v[96:111], v[176:179], v[64:71], v16
    v_exp_f32 v76, v76
    v_exp_f32 v77, v77
    v_exp_f32 v78, v78
    v_exp_f32 v79, v79
    v_exp_f32 v80, v80
    v_exp_f32 v81, v81
    v_smfmac_f32_32x32x32_bf16 v[96:111], v[180:183], v[72:79], v16
    v_exp_f32 v82, v82
    v_exp_f32 v83, v83
    v_exp_f32 v84, v84
    v_exp_f32 v85, v85
    v_exp_f32 v86, v86
    v_exp_f32 v87, v87
    v_exp_f32 v88, v88
    v_exp_f32 v89, v89
    v_exp_f32 v90, v90
    v_exp_f32 v91, v91
    v_exp_f32 v92, v92
    v_smfmac_f32_32x32x32_bf16 v[112:127], v[184:187], v[80:87], v16
    v_exp_f32 v93, v93
    v_exp_f32 v94, v94
    v_exp_f32 v95, v95
    s_nop 1
    s_waitcnt lgkmcnt(0)
    v_smfmac_f32_32x32x32_bf16 v[112:127], v[188:191], v[88:95], v16
    s_mov_b32 s49, 0
L_combine:
    v_permlane32_swap_b32 v96, v100
    v_permlane32_swap_b32 v97, v101
    s_nop 0
    v_permlane32_swap_b32 v100, v104
    v_permlane32_swap_b32 v101, v105
    s_mov_b32 s44, 0x21800000
    s_mov_b32 s45, 0x5d800000
    s_nop 3
    v_add_f32 v124, v124, v108
    v_pk_add_f32 v[120:121], v[120:121], v[106:107]
    v_rcp_f32 v20, v124
    v_pk_add_f32 v[112:113], v[112:113], v[98:99]
    v_pk_add_f32 v[116:117], v[116:117], v[102:103]
    s_mov_b64 exec, 0xffffffff
    v_pk_add_f32 v[114:115], v[114:115], v[100:101]
    v_pk_add_f32 v[118:119], v[118:119], v[104:105]
    s_not_b64 exec, exec
    v_pk_add_f32 v[114:115], v[114:115], v[96:97]
    v_pk_add_f32 v[118:119], v[118:119], v[100:101]
    s_mov_b64 exec, -1
    v_pk_mul_f32 v[120:121], v[120:121], v[20:21] op_sel_hi:[1,0]
    v_pk_mul_f32 v[112:113], v[112:113], v[20:21] op_sel_hi:[1,0]
    v_pk_mul_f32 v[114:115], v[114:115], v[20:21] op_sel_hi:[1,0]
    v_pk_mul_f32 v[116:117], v[116:117], v[20:21] op_sel_hi:[1,0]
    v_pk_mul_f32 v[118:119], v[118:119], v[20:21] op_sel_hi:[1,0]
    v_cvt_pk_bf16_f32 v28, v120, v121
    ds_write_b32 v208, v28 offset:32
    v_cvt_pk_bf16_f32 v24, v112, v113
    v_cvt_pk_bf16_f32 v25, v114, v115
    ds_write2_b32 v208, v24, v25 offset0:0 offset1:1
    v_cvt_pk_bf16_f32 v26, v116, v117
    v_cvt_pk_bf16_f32 v27, v118, v119
    ds_write2_b32 v208, v26, v27 offset0:4 offset1:5
    ds_read_b128 v[32:35], v209
    ds_read_b128 v[36:39], v210 offset:1024
    v_pk_mul_f32 v[22:23], v[112:113], 0 op_sel_hi:[1,0]
    v_cmp_le_f32 s[4:5], s44, v124
    v_pk_fma_f32 v[22:23], v[114:115], 0, v[22:23] op_sel_hi:[1,0,1]
    v_cmp_ge_f32 s[6:7], s45, v124
    v_pk_fma_f32 v[22:23], v[116:117], 0, v[22:23] op_sel_hi:[1,0,1]
    v_pk_fma_f32 v[22:23], v[118:119], 0, v[22:23] op_sel_hi:[1,0,1]
    v_pk_fma_f32 v[22:23], v[120:121], 0, v[22:23] op_sel_hi:[1,0,1]
    s_nop 0
    s_and_b64 s[4:5], s[4:5], s[6:7]
    v_add_f32 v22, v22, v23
    v_cmp_eq_f32 vcc, 0, v22
    s_or_b32 s8, s49, 0
    s_cselect_b64 s[6:7], -1, 0
    s_nop 1
    s_and_b64 s[4:5], s[4:5], vcc
    s_or_b64 s[4:5], s[4:5], s[6:7]
    s_cmp_eq_u64 s[4:5], -1
    s_cbranch_scc0 L_fallback
    s_waitcnt lgkmcnt(1)
    buffer_store_dwordx4 v[32:35], v3, s[28:31], s33 offen sc0 sc1
    s_mov_b64 exec, 0xff
    s_waitcnt lgkmcnt(0)
    buffer_store_dwordx4 v[36:39], v3, s[28:31], s33 offen offset:1024 sc0 sc1
L_end:
    s_endpgm
L_fallback:
    s_waitcnt lgkmcnt(0)
    v_mov_b32 v192, v156
    v_mov_b32 v193, 0
    v_mov_b32 v194, 0xff800000
    v_mov_b32 v22, v4
    v_mov_b32 v23, v6
    s_mov_b32 s48, 32
L_fb1:
    ds_read_b64 v[128:129], v22 offset:40
    ds_read_b64 v[130:131], v22 offset:48
    ds_read_b64 v[132:133], v22
    ds_read_b64 v[134:135], v22 offset:8
    ds_read_b32 v144, v23
    s_waitcnt lgkmcnt(0)
    v_mfma_f32_32x32x16_bf16 v[32:47], v[128:131], v[148:151], 0
    v_mfma_f32_32x32x16_bf16 v[48:63], v[132:135], v[152:155], 0
    s_nop 15
    v_mfma_f32_32x32x4_2b_bf16 v[32:63], v[144:145], v[192:193], v[32:63]
    s_nop 15
    s_nop 7
    v_max3_f32 v194, v194, v32, v33
    v_max3_f32 v194, v194, v34, v35
    v_max3_f32 v194, v194, v36, v37
    v_max3_f32 v194, v194, v38, v39
    v_max3_f32 v194, v194, v40, v41
    v_max3_f32 v194, v194, v42, v43
    v_max3_f32 v194, v194, v44, v45
    v_max3_f32 v194, v194, v46, v47
    v_max3_f32 v194, v194, v48, v49
    v_max3_f32 v194, v194, v50, v51
    v_max3_f32 v194, v194, v52, v53
    v_max3_f32 v194, v194, v54, v55
    v_max3_f32 v194, v194, v56, v57
    v_max3_f32 v194, v194, v58, v59
    v_max3_f32 v194, v194, v60, v61
    v_max3_f32 v194, v194, v62, v63
    v_add_u32 v22, 2304, v22
    v_add_u32 v23, 2304, v23
    s_sub_u32 s48, s48, 1
    s_cmp_lg_u32 s48, 0
    s_cbranch_scc1 L_fb1
    v_mov_b32 v195, v194
    s_nop 1
    v_permlane32_swap_b32 v194, v195
    s_nop 1
    v_max_f32 v194, v194, v195
    v_mov_b32 v96, 0
    v_mov_b32 v112, 0
    v_mov_b32 v97, 0
    v_mov_b32 v113, 0
    v_mov_b32 v98, 0
    v_mov_b32 v114, 0
    v_mov_b32 v99, 0
    v_mov_b32 v115, 0
    v_mov_b32 v100, 0
    v_mov_b32 v116, 0
    v_mov_b32 v101, 0
    v_mov_b32 v117, 0
    v_mov_b32 v102, 0
    v_mov_b32 v118, 0
    v_mov_b32 v103, 0
    v_mov_b32 v119, 0
    v_mov_b32 v104, 0
    v_mov_b32 v120, 0
    v_mov_b32 v105, 0
    v_mov_b32 v121, 0
    v_mov_b32 v106, 0
    v_mov_b32 v122, 0
    v_mov_b32 v107, 0
    v_mov_b32 v123, 0
    v_mov_b32 v108, 0
    v_mov_b32 v124, 0
    v_mov_b32 v109, 0
    v_mov_b32 v125, 0
    v_mov_b32 v110, 0
    v_mov_b32 v126, 0
    v_mov_b32 v111, 0
    v_mov_b32 v127, 0
    v_mov_b32 v22, v4
    v_mov_b32 v23, v6
    v_mov_b32 v24, v8
    v_sub_u32 v25, v9, v8
    v_lshrrev_b32 v25, 1, v25
    s_mov_b32 s48, 32
L_fb2:
    ds_read_b64_tr_b16 v[160:161], v24 offset:32
    ds_read_b64_tr_b16 v[162:163], v24 offset:320
    ds_read_b64_tr_b16 v[164:165], v24 offset:1184
    ds_read_b64_tr_b16 v[166:167], v24 offset:1472
    ds_read_b64_tr_b16 v[168:169], v24 offset:0
    ds_read_b64_tr_b16 v[170:171], v24 offset:288
    ds_read_b64_tr_b16 v[172:173], v24 offset:1152
    ds_read_b64_tr_b16 v[174:175], v24 offset:1440
    ds_read_b64 v[128:129], v22 offset:40
    ds_read_b64 v[130:131], v22 offset:48
    ds_read_b64 v[132:133], v22
    ds_read_b64 v[134:135], v22 offset:8
    ds_read_b32 v144, v23
    s_waitcnt lgkmcnt(0)
    v_mfma_f32_32x32x16_bf16 v[32:47], v[128:131], v[148:151], 0
    v_mfma_f32_32x32x16_bf16 v[48:63], v[132:135], v[152:155], 0
    s_nop 15
    v_mfma_f32_32x32x4_2b_bf16 v[32:63], v[144:145], v[192:193], v[32:63]
    s_nop 15
    s_nop 7
    v_sub_f32 v32, v32, v194
    v_sub_f32 v33, v33, v194
    v_sub_f32 v34, v34, v194
    v_sub_f32 v35, v35, v194
    v_sub_f32 v36, v36, v194
    v_sub_f32 v37, v37, v194
    v_sub_f32 v38, v38, v194
    v_sub_f32 v39, v39, v194
    v_sub_f32 v40, v40, v194
    v_sub_f32 v41, v41, v194
    v_sub_f32 v42, v42, v194
    v_sub_f32 v43, v43, v194
    v_sub_f32 v44, v44, v194
    v_sub_f32 v45, v45, v194
    v_sub_f32 v46, v46, v194
    v_sub_f32 v47, v47, v194
    v_sub_f32 v48, v48, v194
    v_sub_f32 v49, v49, v194
    v_sub_f32 v50, v50, v194
    v_sub_f32 v51, v51, v194
    v_sub_f32 v52, v52, v194
    v_sub_f32 v53, v53, v194
    v_sub_f32 v54, v54, v194
    v_sub_f32 v55, v55, v194
    v_sub_f32 v56, v56, v194
    v_sub_f32 v57, v57, v194
    v_sub_f32 v58, v58, v194
    v_sub_f32 v59, v59, v194
    v_sub_f32 v60, v60, v194
    v_sub_f32 v61, v61, v194
    v_sub_f32 v62, v62, v194
    v_sub_f32 v63, v63, v194
    v_exp_f32 v32, v32
    v_exp_f32 v33, v33
    v_exp_f32 v34, v34
    v_exp_f32 v35, v35
    v_exp_f32 v36, v36
    v_exp_f32 v37, v37
    v_exp_f32 v38, v38
    v_exp_f32 v39, v39
    v_exp_f32 v40, v40
    v_exp_f32 v41, v41
    v_exp_f32 v42, v42
    v_exp_f32 v43, v43
    v_exp_f32 v44, v44
    v_exp_f32 v45, v45
    v_exp_f32 v46, v46
    v_exp_f32 v47, v47
    v_exp_f32 v48, v48
    v_exp_f32 v49, v49
    v_exp_f32 v50, v50
    v_exp_f32 v51, v51
    v_exp_f32 v52, v52
    v_exp_f32 v53, v53
    v_exp_f32 v54, v54
    v_exp_f32 v55, v55
    v_exp_f32 v56, v56
    v_exp_f32 v57, v57
    v_exp_f32 v58, v58
    v_exp_f32 v59, v59
    v_exp_f32 v60, v60
    v_exp_f32 v61, v61
    v_exp_f32 v62, v62
    v_exp_f32 v63, v63
    s_nop 1
    v_smfmac_f32_32x32x32_bf16 v[96:111], v[160:163], v[32:39], v16
    v_smfmac_f32_32x32x32_bf16 v[96:111], v[164:167], v[40:47], v16
    v_smfmac_f32_32x32x32_bf16 v[112:127], v[168:171], v[48:55], v16
    v_smfmac_f32_32x32x32_bf16 v[112:127], v[172:175], v[56:63], v16
    s_nop 7
    v_add_u32 v22, 2304, v22
    v_add_u32 v23, 2304, v23
    v_add_u32 v24, v25, v24
    s_sub_u32 s48, s48, 1
    s_cmp_lg_u32 s48, 0
    s_cbranch_scc1 L_fb2
    s_nop 15
    s_mov_b32 s49, 1
    s_branch L_combine
.section .rodata,"a"
.p2align 6
.amdhsa_kernel standalone__fused_io_aware_attn__prompt_kernel
  .amdhsa_next_free_vgpr 212
  .amdhsa_next_free_sgpr 102
  .amdhsa_accum_offset 212
  .amdhsa_group_segment_fixed_size 0
  .amdhsa_kernarg_size 48
  .amdhsa_user_sgpr_count 2
  .amdhsa_user_sgpr_kernarg_segment_ptr 1
  .amdhsa_system_sgpr_workgroup_id_x 1
.end_amdhsa_kernel
```
